```python
import torch

def _softmax(x, axis=-1):
    return torch.softmax(x, dim=axis)
def _gelu(x):
    return torch.nn.functional.gelu(x, approximate="tanh")
def _silu(x):
    return torch.nn.functional.silu(x)
def _sigmoid(x):
    return torch.sigmoid(x)
def _layernorm(x, axis=-1, eps=1e-5):
    m = x.mean(dim=axis, keepdim=True)
    v = x.var(dim=axis, keepdim=True, unbiased=False)
    return (x - m) / torch.sqrt(v + eps)
def _scatter_add(tgt, idx, src, axis=0):
    return tgt.clone().index_add_(axis, idx, src)
def _segment_sum(src, seg, n):
    out = torch.zeros((n,) + src.shape[1:], dtype=src.dtype)
    return out.index_add_(0, seg, src)
def _pad(x, pw):
    flat = tuple(v for pair in reversed(pw) for v in pair)
    return torch.nn.functional.pad(x, flat)

kernel_name = 'concat_heads__sliding_local_dilated__sliding_local_dilated__prompt'

def setup_inputs():

    _w = (lambda a: (lambda t: t.to(torch.bfloat16) if t.is_floating_point() else t)(torch.as_tensor(a)))
    def _A_setup():
        B, S, D = 1, 2048, 512
        return {
            "x": _w((lambda *s: torch.randn(*s, dtype=torch.bfloat16) * 0.2)(B, S, D)),
            "wqkv": _w((lambda *s: torch.randn(*s, dtype=torch.bfloat16) * 0.2)(D, 3 * D)),
            "wo": _w((lambda *s: torch.randn(*s, dtype=torch.bfloat16) * 0.05)(D, D)),
        }
    _A_in = _A_setup()

    def _B_setup():
        B, S, D = 1, 2048, 512
        return {
            "x": _w((lambda *s: torch.randn(*s, dtype=torch.bfloat16) * 0.2)(B, S, D)),
            "wqkv": _w((lambda *s: torch.randn(*s, dtype=torch.bfloat16) * 0.2)(D, 3 * D)),
            "wo": _w((lambda *s: torch.randn(*s, dtype=torch.bfloat16) * 0.05)(D, D)),
        }
    _B_in = _B_setup()

    return {
        "A_x": _A_in["x"],
        "A_wqkv": _A_in["wqkv"],
        "A_wo": _A_in["wo"],
        "B_x": _B_in["x"],
        "B_wqkv": _B_in["wqkv"],
        "B_wo": _B_in["wo"],
    }

def reference(A_x, A_wqkv, A_wo, B_x, B_wqkv, B_wo):
    def _A_ref(x, wqkv, wo):
        B, S, D = x.shape
        H = 32; Dh = D // H
        W, dil = 8, 2
        qkv = (lambda x, *d: x.permute(*d))((x @ wqkv).reshape(B, S, 3, H, Dh), 2, 0, 3, 1, 4)
        q, k, v = qkv[0], qkv[1], qkv[2]
        scale = Dh ** -0.5
        pos = torch.arange(S)
        off = torch.arange(W) * dil
        idx = pos[:, None] - off[None, :]
        mask = idx >= 0
        idx_c = torch.where(mask, idx, 0).reshape(-1)
        kg = k[:, :, idx_c, :].reshape(B, H, S, W, Dh)
        vg = v[:, :, idx_c, :].reshape(B, H, S, W, Dh)
        logits = torch.einsum("bhsd,bhswd->bhsw", q, kg) * scale
        logits = torch.where(mask[None, None, :, :], logits, -1e9)
        attn = _softmax(logits, axis=-1)
        o = torch.einsum("bhsw,bhswd->bhsd", attn, vg)
        return (lambda x, *d: x.permute(*d))(o, 0, 2, 1, 3).reshape(B, S, D) @ wo

    def _B_ref(x, wqkv, wo):
        B, S, D = x.shape
        H = 32; Dh = D // H
        W, dil = 8, 2
        qkv = (lambda x, *d: x.permute(*d))((x @ wqkv).reshape(B, S, 3, H, Dh), 2, 0, 3, 1, 4)
        q, k, v = qkv[0], qkv[1], qkv[2]
        scale = Dh ** -0.5
        pos = torch.arange(S)
        off = torch.arange(W) * dil
        idx = pos[:, None] - off[None, :]
        mask = idx >= 0
        idx_c = torch.where(mask, idx, 0).reshape(-1)
        kg = k[:, :, idx_c, :].reshape(B, H, S, W, Dh)
        vg = v[:, :, idx_c, :].reshape(B, H, S, W, Dh)
        logits = torch.einsum("bhsd,bhswd->bhsw", q, kg) * scale
        logits = torch.where(mask[None, None, :, :], logits, -1e9)
        attn = _softmax(logits, axis=-1)
        o = torch.einsum("bhsw,bhswd->bhsd", attn, vg)
        return (lambda x, *d: x.permute(*d))(o, 0, 2, 1, 3).reshape(B, S, D) @ wo

    a = _A_ref(A_x, A_wqkv, A_wo)
    b = _B_ref(B_x, B_wqkv, B_wo)
    return torch.concatenate([a, b], axis=-1)
```

```asm
; @launch grid=(256,1,1) block=(256,1,1) lds=158720
.amdgcn_target "amdgcn-amd-amdhsa--gfx950"
.text
.p2align 12
.globl concat_heads__sliding_local_dilated__sliding_local_dilated__prompt_kernel
.p2align 8
.type concat_heads__sliding_local_dilated__sliding_local_dilated__prompt_kernel,@function
concat_heads__sliding_local_dilated__sliding_local_dilated__prompt_kernel:
    s_cmp_ge_u32 s2, 256
    s_cbranch_scc1 L_end
    s_load_dwordx16 s[4:19], s[0:1], 0
    s_getpc_b64 s[60:61]
L_pc:
    s_bfe_u32 s62, s2, 0x20003
    s_lshl_b32 s62, s62, 12
    v_lshrrev_b32 v2, 6, v0
    v_and_b32 v3, 7, v0
    v_lshl_add_u32 v2, v2, 3, v3
    v_lshl_add_u32 v2, v2, 7, s62
    v_min_u32 v2, L_last-L_pc, v2
    v_mov_b32 v3, s61
    v_add_co_u32 v2, vcc, s60, v2
    s_nop 1
    v_addc_co_u32 v3, vcc, 0, v3, vcc
    s_mov_b64 exec, 0xff
    global_load_dword v14, v[2:3], off
    s_mov_b64 exec, -1
    v_lshrrev_b32 v1, 6, v0
    v_and_b32 v0, 63, v0
    v_readfirstlane_b32 s48, v1
    s_and_b32 s60, s2, 7
    s_lshr_b32 s61, s2, 3
    s_lshr_b32 s49, s60, 2
    s_lshr_b32 s59, s61, 3
    s_and_b32 s52, s61, 7
    s_xor_b32 s3, s59, s52
    s_and_b32 s3, s3, 1
    s_lshl_b32 s3, s3, 1
    s_and_b32 s61, s2, 3
    s_lshl_b32 s61, s61, 2
    s_lshr_b32 s61, 0x5410, s61
    s_and_b32 s61, s61, 7
    s_xor_b32 s3, s3, s61
    v_lshrrev_b32 v220, 3, v0
    v_lshrrev_b32 v221, 4, v0
    v_and_b32 v222, 7, v0
    v_and_b32 v221, 1, v221
    v_lshlrev_b32 v221, 1, v221
    v_xor_b32 v221, v221, v222
    v_lshlrev_b32 v15, 4, v221
    v_mul_u32_u24 v223, 3072, v220
    v_add_u32 v221, v15, v223
    s_mul_i32 s62, s48, 49152
    s_lshl_b32 s63, s52, 7
    s_add_u32 s62, s62, s63
    v_add_u32 v6, s62, v221
    s_mul_i32 s56, s48, 10496
    s_xor_b32 s55, s3, 0
    s_lshl_b32 s54, s55, 7
    s_mul_i32 s55, s55, 196608
    s_add_u32 m0, s56, 4096
    s_mov_b32 s30, 0x180000
    s_mov_b32 s31, 0x20000
    s_waitcnt lgkmcnt(0)
    s_cmp_lg_u32 s49, 0
    s_cselect_b32 s28, s12, s6
    s_cselect_b32 s29, s13, s7
    buffer_load_dwordx4 v6, s[28:31], s55 offen offset:1024  lds
    s_load_dwordx2 s[20:21], s[0:1], 64
    v_xor_b32 v7, 64, v6
    v_add_u32 v7, 24576, v7
    s_cselect_b32 s24, s10, s4
    s_cselect_b32 s25, s11, s5
    s_mov_b32 s26, 0x200000
    s_mov_b32 s27, 0x20000
    s_cselect_b32 s32, s14, s8
    s_cselect_b32 s33, s15, s9
    s_mov_b32 s34, 0x80000
    s_mov_b32 s35, 0x20000
    s_and_b32 s60, s60, 3
    s_lshl_b32 s60, s60, 2
    buffer_load_dwordx4 v6, s[28:31], s55 offen offset:2048  lds
    s_add_u32 s60, s60, s59
    s_and_b32 s51, s60, 1
    s_lshr_b32 s50, s60, 1
    s_lshl_b32 s53, s49, 4
    s_add_u32 s53, s53, s60
    s_lshl_b32 s60, s50, 18
    s_lshl_b32 s61, s51, 10
    s_add_u32 s60, s60, s61
    s_lshl_b32 s61, s48, 16
    buffer_load_dwordx4 v6, s[28:31], s55 offen offset:0  lds
    s_add_u32 s61, s61, s60
    v_lshrrev_b32 v221, 4, v0
    v_xor_b32 v223, v222, v221
    v_lshlrev_b32 v223, 4, v223
    v_lshl_add_u32 v223, v220, 11, v223
    v_add_u32 v1, s61, v223
    v_xor_b32 v2, 64, v1
    v_add_u32 v2, 15360, v2
    v_add_u32 v3, 30720, v1
    s_add_u32 m0, s56, 7168
    s_nop 0
    buffer_load_dwordx4 v7, s[28:31], s55 offen offset:1024  lds
    v_add_u32 v4, 30720, v2
    v_lshrrev_b32 v220, 5, v0
    v_bfe_u32 v221, v0, 2, 3
    s_add_u32 s62, s48, 4
    v_xor_b32 v221, s62, v221
    v_lshlrev_b32 v221, 4, v221
    v_and_b32 v222, 3, v0
    v_lshl_add_u32 v221, v222, 2, v221
    v_lshl_add_u32 v221, v220, 11, v221
    buffer_load_dwordx4 v7, s[28:31], s55 offen offset:2048  lds
    s_lshl_b32 s62, s48, 12
    s_add_u32 s62, s62, s60
    s_sub_u32 s62, s62, 19456
    v_add_u32 v5, s62, v221
    buffer_load_dwordx4 v7, s[28:31], s55 offen offset:0  lds
    buffer_load_dword v5, s[24:27], s54 offen offset:3072  lds
    s_add_u32 m0, s56, 0
    s_nop 0
    buffer_load_dwordx4 v1, s[24:27], s54 offen offset:0  lds
    buffer_load_dwordx4 v2, s[24:27], s54 offen offset:1024  lds
    buffer_load_dwordx4 v3, s[24:27], s54 offen offset:2048  lds
    buffer_load_dwordx4 v4, s[24:27], s54 offen offset:3072  lds
    s_lshl_b32 s61, s53, 11
    s_add_u32 s61, s61, 6291456
    s_lshl_b32 s60, s52, 6
    s_add_u32 s60, s60, s48
    s_lshl_b32 s62, s60, 2
    s_add_u32 s62, s62, s61
    v_lshl_add_u32 v27, v0, 25, s62
    v_bfe_u32 v220, v0, 2, 3
    v_and_b32 v221, 3, v0
    v_lshlrev_b32 v221, 2, v221
    v_lshl_add_u32 v221, v220, 8, v221
    v_add_u32 v26, s61, v221
    s_cmp_eq_u32 s60, 0
    s_cselect_b32 s61, s61, 0x40000000
    v_lshrrev_b32 v220, 1, v0
    v_and_b32 v221, 1, v0
    v_lshlrev_b32 v221, 4, v221
    v_lshl_add_u32 v221, v220, 7, v221
    v_lshrrev_b32 v220, 5, v0
    v_lshl_add_u32 v221, v220, 30, v221
    v_add_u32 v31, s61, v221
    v_mov_b32 v236, 0
    v_mov_b32 v237, 0
    v_mov_b32 v238, 0
    v_mov_b32 v239, 0
    s_waitcnt lgkmcnt(0)
    s_mov_b32 s40, s20
    s_and_b32 s41, s21, 0xffff
    s_mov_b32 s42, 0x1000000
    s_mov_b32 s43, 0x20000
    s_mov_b32 s36, s16
    s_and_b32 s37, s17, 0xffff
    s_mov_b32 s38, 0x400000
    s_mov_b32 s39, 0x20000
    s_mov_b32 s44, s18
    s_and_b32 s45, s19, 0xffff
    s_mov_b32 s46, 0x100
    s_mov_b32 s47, 0x20000
    buffer_store_dwordx4 v[236:239], v31, s[40:43], 0 offen sc1
    v_and_b32 v220, 15, v0
    v_lshrrev_b32 v221, 4, v0
    v_lshrrev_b32 v222, 1, v220
    v_xor_b32 v223, v221, v222
    v_lshlrev_b32 v223, 4, v223
    v_lshl_add_u32 v8, v220, 7, v223
    v_xor_b32 v9, 64, v8
    v_and_b32 v222, 3, v222
    v_or_b32 v223, 4, v222
    v_xor_b32 v223, v223, v221
    v_lshlrev_b32 v223, 4, v223
    v_and_b32 v224, 1, v0
    v_lshl_add_u32 v223, v224, 7, v223
    v_mul_u32_u24 v222, 10496, v222
    v_add_u32 v223, v223, v222
    v_add_u32 v10, 10240, v223
    v_xor_b32 v11, 64, v10
    v_bfe_u32 v220, v0, 2, 2
    v_lshrrev_b32 v222, 1, v220
    v_and_b32 v223, 1, v221
    v_lshl_add_u32 v222, v223, 1, v222
    v_lshlrev_b32 v222, 5, v222
    v_and_b32 v224, 3, v0
    v_lshl_add_u32 v222, v224, 3, v222
    v_lshl_add_u32 v222, v220, 7, v222
    v_lshl_add_u32 v224, v221, 10, v222
    v_add_u32 v19, 93184, v224
    v_xor_b32 v20, 32, v19
    v_xor_b32 v21, 64, v19
    v_xor_b32 v22, 96, v19
    s_lshl_b32 s60, s48, 5
    v_xor_b32 v222, s60, v222
    v_mul_u32_u24 v223, 3072, v223
    v_add_u32 v222, v222, v223
    v_lshrrev_b32 v223, 1, v221
    v_mul_u32_u24 v223, 10496, v223
    v_add_u32 v222, v222, v223
    v_add_u32 v12, 4096, v222
    v_lshrrev_b32 v220, 3, v0
    v_lshl_add_u32 v220, v220, 10, v15
    s_lshl_b32 s60, s52, 7
    s_lshl_b32 s61, s48, 16
    s_add_u32 s61, s61, s60
    v_add_u32 v15, s61, v220
    v_xor_b32 v16, 64, v15
    v_add_u32 v16, 7168, v16
    v_add_u32 v17, 14336, v15
    v_add_u32 v18, 14336, v16
    s_lshl_b32 s19, s48, 13
    s_lshl_b32 s61, s59, 3
    s_add_u32 s61, s61, s52
    s_lshl_b32 s61, s61, 14
    s_lshl_b32 s62, s48, 12
    s_add_u32 s61, s61, s62
    v_and_b32 v220, 31, v0
    v_lshl_add_u32 v28, v220, 7, s61
    s_mul_i32 s62, s53, 131072
    s_mul_i32 s63, s48, 16384
    s_add_u32 s63, s62, s63
    v_lshl_add_u32 v24, v0, 4, s63
    s_lshl_b32 s61, s52, 2
    s_add_u32 s61, s61, s48
    s_lshl_b32 s61, s61, 9
    s_add_u32 s61, s61, s62
    v_and_b32 v220, 15, v0
    v_lshrrev_b32 v221, 5, v0
    v_bfe_u32 v222, v0, 4, 1
    v_lshlrev_b32 v223, 4, v220
    v_lshl_add_u32 v223, v221, 8, v223
    v_mul_u32_u24 v23, 16384, v222
    v_add3_u32 v23, s61, v223, v23
    s_lshl_b32 s62, s50, 19
    s_lshl_b32 s63, s48, 16
    s_add_u32 s62, s62, s63
    s_lshl_b32 s63, s51, 11
    s_add_u32 s62, s62, s63
    s_lshl_b32 s63, s49, 10
    s_add_u32 s62, s62, s63
    s_add_u32 s62, s62, s60
    v_lshlrev_b32 v222, 5, v222
    v_lshl_add_u32 v222, v221, 4, v222
    v_lshl_add_u32 v222, v220, 12, v222
    v_add_u32 v25, s62, v222
    v_lshrrev_b32 v222, 3, v0
    v_and_b32 v223, 7, v0
    v_lshlrev_b32 v223, 4, v223
    v_lshl_add_u32 v222, v222, 12, v223
    v_add_u32 v25, s62, v222
    v_bfe_u32 v220, v0, 2, 3
    v_and_b32 v221, 3, v0
    v_mul_u32_u24 v220, 16384, v220
    v_lshl_add_u32 v220, v221, 7, v220
    v_add_u32 v255, s61, v220
    s_getreg_b32 s8, hwreg(HW_REG_XCC_ID, 0, 4)
    s_add_u32 s8, s8, 1
    v_mov_b32 v30, s8
    s_lshl_b32 s12, s53, 3
    s_or_b32 s61, s52, s48
    s_cmp_eq_u32 s61, 0
    s_cselect_b32 s61, s12, 0x40000000
    v_lshl_add_u32 v29, v0, 12, s61
    s_mov_b32 s57, 1
    s_movk_i32 s13, 4096
    s_movk_i32 s14, 8192
    s_movk_i32 s15, 12288
    s_mov_b32 s16, 32768
    s_mov_b32 s17, 65536
    s_mov_b32 s18, 98304
    v_and_b32 v220, 15, v0
    v_lshrrev_b32 v221, 4, v0
    v_lshlrev_b32 v221, 2, v221
    v_sub_u32 v220, v220, v221
    v_mov_b32 v222, 0xff800000
    s_cmp_eq_u32 s50, 0
    s_cselect_b64 s[62:63], -1, 0
    v_subrev_u32 v221, 0, v220
    v_cmp_gt_u32 vcc, 8, v221
    s_nop 1
    v_cndmask_b32 v136, v222, 0, vcc
    v_cmp_gt_i32 vcc, -8, v221
    s_nop 1
    v_cndmask_b32 v140, v222, 0, vcc
    v_cndmask_b32 v144, v140, v222, s[62:63]
    v_mov_b32 v152, 0x3f803f80
    v_subrev_u32 v221, 1, v220
    v_cmp_gt_u32 vcc, 8, v221
    s_nop 1
    v_cndmask_b32 v137, v222, 0, vcc
    v_cmp_gt_i32 vcc, -8, v221
    s_nop 1
    v_cndmask_b32 v141, v222, 0, vcc
    v_cndmask_b32 v145, v141, v222, s[62:63]
    v_mov_b32 v153, 0x3f803f80
    v_subrev_u32 v221, 2, v220
    v_cmp_gt_u32 vcc, 8, v221
    s_nop 1
    v_cndmask_b32 v138, v222, 0, vcc
    v_cmp_gt_i32 vcc, -8, v221
    s_nop 1
    v_cndmask_b32 v142, v222, 0, vcc
    v_cndmask_b32 v146, v142, v222, s[62:63]
    v_mov_b32 v154, 0x3f803f80
    v_subrev_u32 v221, 3, v220
    v_cmp_gt_u32 vcc, 8, v221
    s_nop 1
    v_cndmask_b32 v139, v222, 0, vcc
    v_cmp_gt_i32 vcc, -8, v221
    s_nop 1
    v_cndmask_b32 v143, v222, 0, vcc
    v_cndmask_b32 v147, v143, v222, s[62:63]
    v_mov_b32 v155, 0x3f803f80
    v_and_b32 v221, 40, v0
    v_cmp_eq_u32 vcc, 32, v221
    s_nop 1
    v_cndmask_b32 v150, 0, -1, vcc
    v_not_b32 v148, v150
    s_mov_b32 s22, 0x3eb8aa3b
    s_xor_b32 s55, s3, 1
    s_lshl_b32 s54, s55, 7
    s_mul_i32 s55, s55, 196608
    s_add_u32 m0, s56, 46080
    s_nop 0
    buffer_load_dwordx4 v6, s[28:31], s55 offen offset:1024  lds
    buffer_load_dwordx4 v6, s[28:31], s55 offen offset:2048  lds
    buffer_load_dwordx4 v6, s[28:31], s55 offen offset:0  lds
    s_add_u32 m0, s56, 49152
    s_nop 0
    buffer_load_dwordx4 v7, s[28:31], s55 offen offset:1024  lds
    buffer_load_dwordx4 v7, s[28:31], s55 offen offset:2048  lds
    buffer_load_dwordx4 v7, s[28:31], s55 offen offset:0  lds
    buffer_load_dword v5, s[24:27], s54 offen offset:3072  lds
    s_add_u32 m0, s56, 41984
    s_nop 0
    buffer_load_dwordx4 v1, s[24:27], s54 offen offset:0  lds
    buffer_load_dwordx4 v2, s[24:27], s54 offen offset:1024  lds
    buffer_load_dwordx4 v3, s[24:27], s54 offen offset:2048  lds
    buffer_load_dwordx4 v4, s[24:27], s54 offen offset:3072  lds
    s_waitcnt vmcnt(12)
    s_barrier
    ds_read_b64_tr_b16 a[4:5], v12 offset:1024
    ds_read_b64_tr_b16 a[6:7], v12 offset:1536
    ds_read_b64_tr_b16 a[8:9], v12 offset:2048
    ds_read_b64_tr_b16 a[10:11], v12 offset:2560
    ds_read_b128 a[12:15], v10
    ds_read_b64_tr_b16 a[0:1], v12 offset:0
    ds_read_b64_tr_b16 a[2:3], v12 offset:512
    ds_read_b128 a[16:19], v8 offset:0
    ds_read_b128 a[20:23], v8 offset:2048
    ds_read_b128 a[24:27], v8 offset:10496
    ds_read_b128 a[28:31], v8 offset:12544
    ds_read_b128 a[32:35], v8 offset:20992
    ds_read_b128 a[36:39], v8 offset:23040
    ds_read_b128 a[40:43], v8 offset:31488
    ds_read_b128 a[44:47], v8 offset:33536
    s_waitcnt lgkmcnt(10)
    v_mfma_f32_16x16x32_bf16 v[32:35], a[4:7], a[12:15], 0
    s_xor_b32 s55, s3, 2
    s_lshl_b32 s54, s55, 7
    v_mfma_f32_16x16x32_bf16 v[36:39], a[12:15], a[8:11], 0
    ds_read_b64_tr_b16 a[52:53], v12 offset:22016
    s_mul_i32 s55, s55, 196608
    s_waitcnt lgkmcnt(8)
    v_mfma_f32_16x16x32_bf16 v[44:47], a[4:7], a[16:19], 0
    ds_read_b64_tr_b16 a[54:55], v12 offset:22528
    s_add_u32 m0, s56, 88064
    v_mfma_f32_16x16x32_bf16 v[40:43], a[0:3], a[16:19], 0
    ds_read_b64_tr_b16 a[56:57], v12 offset:23040
    buffer_load_dwordx4 v6, s[28:31], s55 offen offset:1024  lds
    v_mfma_f32_16x16x32_bf16 v[48:51], a[16:19], a[8:11], 0
    ds_read_b64_tr_b16 a[58:59], v12 offset:23552
    buffer_load_dwordx4 v6, s[28:31], s55 offen offset:2048  lds
    s_waitcnt lgkmcnt(10)
    v_mfma_f32_16x16x32_bf16 v[56:59], a[4:7], a[20:23], 0
    ds_read_b128 a[60:63], v11
    v_mfma_f32_16x16x32_bf16 v[52:55], a[0:3], a[20:23], 0
    ds_read_b64_tr_b16 a[48:49], v12 offset:20992
    v_mfma_f32_16x16x32_bf16 v[60:63], a[20:23], a[8:11], 0
    ds_read_b64_tr_b16 a[50:51], v12 offset:21504
    s_waitcnt lgkmcnt(12)
    v_mfma_f32_16x16x32_bf16 v[68:71], a[4:7], a[24:27], 0
    ds_read_b128 a[64:67], v9 offset:0
    v_mfma_f32_16x16x32_bf16 v[64:67], a[0:3], a[24:27], 0
    ds_read_b128 a[68:71], v9 offset:2048
    buffer_load_dwordx4 v6, s[28:31], s55 offen offset:0  lds
    v_mfma_f32_16x16x32_bf16 v[72:75], a[24:27], a[8:11], 0
    ds_read_b128 a[72:75], v9 offset:10496
    s_waitcnt lgkmcnt(14)
    v_mfma_f32_16x16x32_bf16 v[80:83], a[4:7], a[28:31], 0
    ds_read_b128 a[76:79], v9 offset:12544
    v_mfma_f32_16x16x32_bf16 v[76:79], a[0:3], a[28:31], 0
    ds_read_b128 a[80:83], v9 offset:20992
    v_mfma_f32_16x16x32_bf16 v[84:87], a[28:31], a[8:11], 0
    ds_read_b128 a[84:87], v9 offset:23040
    s_add_u32 m0, s56, 91136
    s_waitcnt lgkmcnt(14)
    v_mfma_f32_16x16x32_bf16 v[92:95], a[4:7], a[32:35], 0
    ds_read_b128 a[88:91], v9 offset:31488
    buffer_load_dwordx4 v7, s[28:31], s55 offen offset:1024  lds
    v_mfma_f32_16x16x32_bf16 v[88:91], a[0:3], a[32:35], 0
    ds_read_b128 a[92:95], v9 offset:33536
    v_mfma_f32_16x16x32_bf16 v[96:99], a[32:35], a[8:11], 0
    v_add_u32 v12, 0xa400, v12
    v_mfma_f32_16x16x32_bf16 v[104:107], a[4:7], a[36:39], 0
    v_add_u32 v10, 0xa400, v10
    v_mfma_f32_16x16x32_bf16 v[100:103], a[0:3], a[36:39], 0
    v_add_u32 v8, 0xa400, v8
    buffer_load_dwordx4 v7, s[28:31], s55 offen offset:2048  lds
    v_mfma_f32_16x16x32_bf16 v[108:111], a[36:39], a[8:11], 0
    v_add_u32 v11, 0xa400, v11
    v_mfma_f32_16x16x32_bf16 v[116:119], a[4:7], a[40:43], 0
    v_add_u32 v9, 0xa400, v9
    v_mfma_f32_16x16x32_bf16 v[112:115], a[0:3], a[40:43], 0
    v_mfma_f32_16x16x32_bf16 v[120:123], a[40:43], a[8:11], 0
    s_waitcnt lgkmcnt(14)
    v_mfma_f32_16x16x32_bf16 v[128:131], a[4:7], a[44:47], 0
    buffer_load_dwordx4 v7, s[28:31], s55 offen offset:0  lds
    v_mfma_f32_16x16x32_bf16 v[124:127], a[0:3], a[44:47], 0
    v_mfma_f32_16x16x32_bf16 v[132:135], a[44:47], a[8:11], 0
    s_waitcnt lgkmcnt(10)
    v_mfma_f32_16x16x32_bf16 v[32:35], a[52:55], a[60:63], v[32:35]
    v_mfma_f32_16x16x32_bf16 v[36:39], a[60:63], a[56:59], v[36:39]
    s_waitcnt lgkmcnt(7)
    v_mfma_f32_16x16x32_bf16 v[44:47], a[52:55], a[64:67], v[44:47]
    buffer_load_dword v5, s[24:27], s54 offen offset:3072  lds
    v_mfma_f32_16x16x32_bf16 v[40:43], a[48:51], a[64:67], v[40:43]
    v_mfma_f32_16x16x32_bf16 v[48:51], a[64:67], a[56:59], v[48:51]
    s_waitcnt lgkmcnt(6)
    v_mfma_f32_16x16x32_bf16 v[56:59], a[52:55], a[68:71], v[56:59]
    v_mfma_f32_16x16x32_bf16 v[52:55], a[48:51], a[68:71], v[52:55]
    s_add_u32 m0, s56, 83968
    v_mfma_f32_16x16x32_bf16 v[60:63], a[68:71], a[56:59], v[60:63]
    buffer_load_dwordx4 v1, s[24:27], s54 offen offset:0  lds
    s_waitcnt lgkmcnt(5)
    v_mfma_f32_16x16x32_bf16 v[68:71], a[52:55], a[72:75], v[68:71]
    v_mfma_f32_16x16x32_bf16 v[64:67], a[48:51], a[72:75], v[64:67]
    v_mfma_f32_16x16x32_bf16 v[72:75], a[72:75], a[56:59], v[72:75]
    s_waitcnt lgkmcnt(4)
    v_mfma_f32_16x16x32_bf16 v[80:83], a[52:55], a[76:79], v[80:83]
    buffer_load_dwordx4 v2, s[24:27], s54 offen offset:1024  lds
    v_mfma_f32_16x16x32_bf16 v[76:79], a[48:51], a[76:79], v[76:79]
    v_mfma_f32_16x16x32_bf16 v[84:87], a[76:79], a[56:59], v[84:87]
    s_waitcnt lgkmcnt(3)
    v_mfma_f32_16x16x32_bf16 v[92:95], a[52:55], a[80:83], v[92:95]
    v_mfma_f32_16x16x32_bf16 v[88:91], a[48:51], a[80:83], v[88:91]
    v_mfma_f32_16x16x32_bf16 v[96:99], a[80:83], a[56:59], v[96:99]
    buffer_load_dwordx4 v3, s[24:27], s54 offen offset:2048  lds
    s_waitcnt lgkmcnt(2)
    v_mfma_f32_16x16x32_bf16 v[104:107], a[52:55], a[84:87], v[104:107]
    v_mfma_f32_16x16x32_bf16 v[100:103], a[48:51], a[84:87], v[100:103]
    v_mfma_f32_16x16x32_bf16 v[108:111], a[84:87], a[56:59], v[108:111]
    s_waitcnt lgkmcnt(1)
    v_mfma_f32_16x16x32_bf16 v[116:119], a[52:55], a[88:91], v[116:119]
    v_mfma_f32_16x16x32_bf16 v[112:115], a[48:51], a[88:91], v[112:115]
    buffer_load_dwordx4 v4, s[24:27], s54 offen offset:3072  lds
    v_mfma_f32_16x16x32_bf16 v[120:123], a[88:91], a[56:59], v[120:123]
    s_waitcnt lgkmcnt(0)
    v_mfma_f32_16x16x32_bf16 v[128:131], a[52:55], a[92:95], v[128:131]
    v_mfma_f32_16x16x32_bf16 v[124:127], a[48:51], a[92:95], v[124:127]
    v_mfma_f32_16x16x32_bf16 v[132:135], a[92:95], a[56:59], v[132:135]
    s_waitcnt vmcnt(11) lgkmcnt(0)
    s_barrier
    ds_read_b64_tr_b16 a[4:5], v12 offset:1024
    ds_read_b64_tr_b16 a[6:7], v12 offset:1536
    ds_read_b64_tr_b16 a[8:9], v12 offset:2048
    ds_read_b64_tr_b16 a[10:11], v12 offset:2560
    ds_read_b128 a[12:15], v10
    ds_read_b64_tr_b16 a[0:1], v12 offset:0
    ds_read_b64_tr_b16 a[2:3], v12 offset:512
    ds_read_b128 a[16:19], v8 offset:0
    ds_read_b128 a[20:23], v8 offset:2048
    ds_read_b128 a[24:27], v8 offset:10496
    ds_read_b128 a[28:31], v8 offset:12544
    ds_read_b128 a[32:35], v8 offset:20992
    ds_read_b128 a[36:39], v8 offset:23040
    ds_read_b128 a[40:43], v8 offset:31488
    ds_read_b128 a[44:47], v8 offset:33536
    s_waitcnt lgkmcnt(10)
    v_mfma_f32_16x16x32_bf16 v[32:35], a[4:7], a[12:15], v[32:35]
    s_xor_b32 s55, s3, 3
    s_lshl_b32 s54, s55, 7
    s_mul_i32 s55, s55, 196608
    s_add_u32 m0, s56, 4096
    s_nop 0
    buffer_load_dwordx4 v6, s[28:31], s55 offen offset:1024  lds
    v_mfma_f32_16x16x32_bf16 v[36:39], a[12:15], a[8:11], v[36:39]
    ds_read_b64_tr_b16 a[52:53], v12 offset:22016
    s_waitcnt lgkmcnt(8)
    v_mfma_f32_16x16x32_bf16 v[44:47], a[4:7], a[16:19], v[44:47]
    buffer_load_dwordx4 v6, s[28:31], s55 offen offset:2048  lds
    ds_read_b64_tr_b16 a[54:55], v12 offset:22528
    v_mfma_f32_16x16x32_bf16 v[40:43], a[0:3], a[16:19], v[40:43]
    ds_read_b64_tr_b16 a[56:57], v12 offset:23040
    v_mfma_f32_16x16x32_bf16 v[48:51], a[16:19], a[8:11], v[48:51]
    buffer_load_dwordx4 v6, s[28:31], s55 offen offset:0  lds
    ds_read_b64_tr_b16 a[58:59], v12 offset:23552
    s_waitcnt lgkmcnt(10)
    v_mfma_f32_16x16x32_bf16 v[56:59], a[4:7], a[20:23], v[56:59]
    ds_read_b128 a[60:63], v11
    v_mfma_f32_16x16x32_bf16 v[52:55], a[0:3], a[20:23], v[52:55]
    s_add_u32 m0, s56, 7168
    s_nop 0
    buffer_load_dwordx4 v7, s[28:31], s55 offen offset:1024  lds
    ds_read_b64_tr_b16 a[48:49], v12 offset:20992
    v_mfma_f32_16x16x32_bf16 v[60:63], a[20:23], a[8:11], v[60:63]
    ds_read_b64_tr_b16 a[50:51], v12 offset:21504
    s_waitcnt lgkmcnt(12)
    v_mfma_f32_16x16x32_bf16 v[68:71], a[4:7], a[24:27], v[68:71]
    buffer_load_dwordx4 v7, s[28:31], s55 offen offset:2048  lds
    ds_read_b128 a[64:67], v9 offset:0
    v_mfma_f32_16x16x32_bf16 v[64:67], a[0:3], a[24:27], v[64:67]
    ds_read_b128 a[68:71], v9 offset:2048
    v_mfma_f32_16x16x32_bf16 v[72:75], a[24:27], a[8:11], v[72:75]
    buffer_load_dwordx4 v7, s[28:31], s55 offen offset:0  lds
    ds_read_b128 a[72:75], v9 offset:10496
    s_waitcnt lgkmcnt(14)
    v_mfma_f32_16x16x32_bf16 v[80:83], a[4:7], a[28:31], v[80:83]
    ds_read_b128 a[76:79], v9 offset:12544
    v_mfma_f32_16x16x32_bf16 v[76:79], a[0:3], a[28:31], v[76:79]
    ds_read_b128 a[80:83], v9 offset:20992
    v_mfma_f32_16x16x32_bf16 v[84:87], a[28:31], a[8:11], v[84:87]
    buffer_load_dword v5, s[24:27], s54 offen offset:3072  lds
    ds_read_b128 a[84:87], v9 offset:23040
    s_waitcnt lgkmcnt(14)
    v_mfma_f32_16x16x32_bf16 v[92:95], a[4:7], a[32:35], v[92:95]
    ds_read_b128 a[88:91], v9 offset:31488
    v_mfma_f32_16x16x32_bf16 v[88:91], a[0:3], a[32:35], v[88:91]
    s_add_u32 m0, s56, 0
    s_nop 0
    buffer_load_dwordx4 v1, s[24:27], s54 offen offset:0  lds
    ds_read_b128 a[92:95], v9 offset:33536
    v_mfma_f32_16x16x32_bf16 v[96:99], a[32:35], a[8:11], v[96:99]
    v_add_u32 v12, 0xa400, v12
    v_mfma_f32_16x16x32_bf16 v[104:107], a[4:7], a[36:39], v[104:107]
    buffer_load_dwordx4 v2, s[24:27], s54 offen offset:1024  lds
    v_add_u32 v10, 0xa400, v10
    v_mfma_f32_16x16x32_bf16 v[100:103], a[0:3], a[36:39], v[100:103]
    v_add_u32 v8, 0xa400, v8
    v_mfma_f32_16x16x32_bf16 v[108:111], a[36:39], a[8:11], v[108:111]
    buffer_load_dwordx4 v3, s[24:27], s54 offen offset:2048  lds
    v_add_u32 v11, 0xa400, v11
    v_mfma_f32_16x16x32_bf16 v[116:119], a[4:7], a[40:43], v[116:119]
    v_add_u32 v9, 0xa400, v9
    v_mfma_f32_16x16x32_bf16 v[112:115], a[0:3], a[40:43], v[112:115]
    buffer_load_dwordx4 v4, s[24:27], s54 offen offset:3072  lds
    v_mfma_f32_16x16x32_bf16 v[120:123], a[40:43], a[8:11], v[120:123]
    s_waitcnt lgkmcnt(14)
    v_mfma_f32_16x16x32_bf16 v[128:131], a[4:7], a[44:47], v[128:131]
    buffer_store_dword v30, v29, s[44:47], 0 offen sc1
    v_mfma_f32_16x16x32_bf16 v[124:127], a[0:3], a[44:47], v[124:127]
    v_mfma_f32_16x16x32_bf16 v[132:135], a[44:47], a[8:11], v[132:135]
    s_waitcnt vmcnt(12) lgkmcnt(0)
    s_barrier
    v_mfma_f32_16x16x32_bf16 v[32:35], a[52:55], a[60:63], v[32:35]
    ds_read_b64_tr_b16 a[4:5], v12 offset:1024
    s_xor_b32 s55, s3, 4
    v_mfma_f32_16x16x32_bf16 v[36:39], a[60:63], a[56:59], v[36:39]
    ds_read_b64_tr_b16 a[6:7], v12 offset:1536
    s_lshl_b32 s54, s55, 7
    v_mfma_f32_16x16x32_bf16 v[44:47], a[52:55], a[64:67], v[44:47]
    ds_read_b64_tr_b16 a[8:9], v12 offset:2048
    s_mul_i32 s55, s55, 196608
    v_mfma_f32_16x16x32_bf16 v[40:43], a[48:51], a[64:67], v[40:43]
    ds_read_b64_tr_b16 a[10:11], v12 offset:2560
    s_add_u32 m0, s56, 46080
    v_mfma_f32_16x16x32_bf16 v[48:51], a[64:67], a[56:59], v[48:51]
    ds_read_b128 a[12:15], v10
    buffer_load_dwordx4 v6, s[28:31], s55 offen offset:1024  lds
    v_mfma_f32_16x16x32_bf16 v[56:59], a[52:55], a[68:71], v[56:59]
    ds_read_b64_tr_b16 a[0:1], v12 offset:0
    buffer_load_dwordx4 v6, s[28:31], s55 offen offset:2048  lds
    v_mfma_f32_16x16x32_bf16 v[52:55], a[48:51], a[68:71], v[52:55]
    ds_read_b64_tr_b16 a[2:3], v12 offset:512
    v_mfma_f32_16x16x32_bf16 v[60:63], a[68:71], a[56:59], v[60:63]
    ds_read_b128 a[16:19], v8 offset:0
    v_mfma_f32_16x16x32_bf16 v[68:71], a[52:55], a[72:75], v[68:71]
    ds_read_b128 a[20:23], v8 offset:2048
    v_mfma_f32_16x16x32_bf16 v[64:67], a[48:51], a[72:75], v[64:67]
    ds_read_b128 a[24:27], v8 offset:10496
    buffer_load_dwordx4 v6, s[28:31], s55 offen offset:0  lds
    v_mfma_f32_16x16x32_bf16 v[72:75], a[72:75], a[56:59], v[72:75]
    ds_read_b128 a[28:31], v8 offset:12544
    v_mfma_f32_16x16x32_bf16 v[80:83], a[52:55], a[76:79], v[80:83]
    ds_read_b128 a[32:35], v8 offset:20992
    v_mfma_f32_16x16x32_bf16 v[76:79], a[48:51], a[76:79], v[76:79]
    ds_read_b128 a[36:39], v8 offset:23040
    v_mfma_f32_16x16x32_bf16 v[84:87], a[76:79], a[56:59], v[84:87]
    ds_read_b128 a[40:43], v8 offset:31488
    s_add_u32 m0, s56, 49152
    v_mfma_f32_16x16x32_bf16 v[92:95], a[52:55], a[80:83], v[92:95]
    ds_read_b128 a[44:47], v8 offset:33536
    buffer_load_dwordx4 v7, s[28:31], s55 offen offset:1024  lds
    v_mfma_f32_16x16x32_bf16 v[88:91], a[48:51], a[80:83], v[88:91]
    v_mfma_f32_16x16x32_bf16 v[96:99], a[80:83], a[56:59], v[96:99]
    v_mfma_f32_16x16x32_bf16 v[104:107], a[52:55], a[84:87], v[104:107]
    v_mfma_f32_16x16x32_bf16 v[100:103], a[48:51], a[84:87], v[100:103]
    buffer_load_dwordx4 v7, s[28:31], s55 offen offset:2048  lds
    v_mfma_f32_16x16x32_bf16 v[108:111], a[84:87], a[56:59], v[108:111]
    v_mfma_f32_16x16x32_bf16 v[116:119], a[52:55], a[88:91], v[116:119]
    v_mfma_f32_16x16x32_bf16 v[112:115], a[48:51], a[88:91], v[112:115]
    v_mfma_f32_16x16x32_bf16 v[120:123], a[88:91], a[56:59], v[120:123]
    v_mfma_f32_16x16x32_bf16 v[128:131], a[52:55], a[92:95], v[128:131]
    buffer_load_dwordx4 v7, s[28:31], s55 offen offset:0  lds
    v_mfma_f32_16x16x32_bf16 v[124:127], a[48:51], a[92:95], v[124:127]
    v_mfma_f32_16x16x32_bf16 v[132:135], a[92:95], a[56:59], v[132:135]
    s_waitcnt lgkmcnt(0)
    v_mfma_f32_16x16x32_bf16 v[32:35], a[4:7], a[12:15], v[32:35]
    ds_read_b64_tr_b16 a[52:53], v12 offset:22016
    v_mfma_f32_16x16x32_bf16 v[36:39], a[12:15], a[8:11], v[36:39]
    ds_read_b64_tr_b16 a[54:55], v12 offset:22528
    v_mfma_f32_16x16x32_bf16 v[44:47], a[4:7], a[16:19], v[44:47]
    ds_read_b64_tr_b16 a[56:57], v12 offset:23040
    buffer_load_dword v5, s[24:27], s54 offen offset:3072  lds
    v_mfma_f32_16x16x32_bf16 v[40:43], a[0:3], a[16:19], v[40:43]
    ds_read_b64_tr_b16 a[58:59], v12 offset:23552
    v_mfma_f32_16x16x32_bf16 v[48:51], a[16:19], a[8:11], v[48:51]
    ds_read_b128 a[60:63], v11
    v_mfma_f32_16x16x32_bf16 v[56:59], a[4:7], a[20:23], v[56:59]
    ds_read_b64_tr_b16 a[48:49], v12 offset:20992
    v_mfma_f32_16x16x32_bf16 v[52:55], a[0:3], a[20:23], v[52:55]
    ds_read_b64_tr_b16 a[50:51], v12 offset:21504
    s_add_u32 m0, s56, 41984
    v_mfma_f32_16x16x32_bf16 v[60:63], a[20:23], a[8:11], v[60:63]
    ds_read_b128 a[64:67], v9 offset:0
    buffer_load_dwordx4 v1, s[24:27], s54 offen offset:0  lds
    v_mfma_f32_16x16x32_bf16 v[68:71], a[4:7], a[24:27], v[68:71]
    ds_read_b128 a[68:71], v9 offset:2048
    v_mfma_f32_16x16x32_bf16 v[64:67], a[0:3], a[24:27], v[64:67]
    ds_read_b128 a[72:75], v9 offset:10496
    v_mfma_f32_16x16x32_bf16 v[72:75], a[24:27], a[8:11], v[72:75]
    ds_read_b128 a[76:79], v9 offset:12544
    v_mfma_f32_16x16x32_bf16 v[80:83], a[4:7], a[28:31], v[80:83]
    ds_read_b128 a[80:83], v9 offset:20992
    buffer_load_dwordx4 v2, s[24:27], s54 offen offset:1024  lds
    v_mfma_f32_16x16x32_bf16 v[76:79], a[0:3], a[28:31], v[76:79]
    ds_read_b128 a[84:87], v9 offset:23040
    v_mfma_f32_16x16x32_bf16 v[84:87], a[28:31], a[8:11], v[84:87]
    ds_read_b128 a[88:91], v9 offset:31488
    v_mfma_f32_16x16x32_bf16 v[92:95], a[4:7], a[32:35], v[92:95]
    ds_read_b128 a[92:95], v9 offset:33536
    v_mfma_f32_16x16x32_bf16 v[88:91], a[0:3], a[32:35], v[88:91]
    v_add_u32 v12, 0xfffeb800, v12
    v_mfma_f32_16x16x32_bf16 v[96:99], a[32:35], a[8:11], v[96:99]
    v_add_u32 v10, 0xfffeb800, v10
    buffer_load_dwordx4 v3, s[24:27], s54 offen offset:2048  lds
    v_mfma_f32_16x16x32_bf16 v[104:107], a[4:7], a[36:39], v[104:107]
    v_add_u32 v8, 0xfffeb800, v8
    v_mfma_f32_16x16x32_bf16 v[100:103], a[0:3], a[36:39], v[100:103]
    v_add_u32 v11, 0xfffeb800, v11
    v_mfma_f32_16x16x32_bf16 v[108:111], a[36:39], a[8:11], v[108:111]
    v_add_u32 v9, 0xfffeb800, v9
    v_mfma_f32_16x16x32_bf16 v[116:119], a[4:7], a[40:43], v[116:119]
    v_mfma_f32_16x16x32_bf16 v[112:115], a[0:3], a[40:43], v[112:115]
    buffer_load_dwordx4 v4, s[24:27], s54 offen offset:3072  lds
    v_mfma_f32_16x16x32_bf16 v[120:123], a[40:43], a[8:11], v[120:123]
    v_mfma_f32_16x16x32_bf16 v[128:131], a[4:7], a[44:47], v[128:131]
    v_mfma_f32_16x16x32_bf16 v[124:127], a[0:3], a[44:47], v[124:127]
    v_mfma_f32_16x16x32_bf16 v[132:135], a[44:47], a[8:11], v[132:135]
    s_waitcnt vmcnt(12) lgkmcnt(0)
    s_barrier
    v_mfma_f32_16x16x32_bf16 v[32:35], a[52:55], a[60:63], v[32:35]
    ds_read_b64_tr_b16 a[4:5], v12 offset:1024
    s_xor_b32 s55, s3, 5
    v_mfma_f32_16x16x32_bf16 v[36:39], a[60:63], a[56:59], v[36:39]
    ds_read_b64_tr_b16 a[6:7], v12 offset:1536
    s_lshl_b32 s54, s55, 7
    v_mfma_f32_16x16x32_bf16 v[44:47], a[52:55], a[64:67], v[44:47]
    ds_read_b64_tr_b16 a[8:9], v12 offset:2048
    s_mul_i32 s55, s55, 196608
    v_mfma_f32_16x16x32_bf16 v[40:43], a[48:51], a[64:67], v[40:43]
    ds_read_b64_tr_b16 a[10:11], v12 offset:2560
    s_add_u32 m0, s56, 88064
    v_mfma_f32_16x16x32_bf16 v[48:51], a[64:67], a[56:59], v[48:51]
    ds_read_b128 a[12:15], v10
    buffer_load_dwordx4 v6, s[28:31], s55 offen offset:1024  lds
    v_mfma_f32_16x16x32_bf16 v[56:59], a[52:55], a[68:71], v[56:59]
    ds_read_b64_tr_b16 a[0:1], v12 offset:0
    buffer_load_dwordx4 v6, s[28:31], s55 offen offset:2048  lds
    v_mfma_f32_16x16x32_bf16 v[52:55], a[48:51], a[68:71], v[52:55]
    ds_read_b64_tr_b16 a[2:3], v12 offset:512
    v_mfma_f32_16x16x32_bf16 v[60:63], a[68:71], a[56:59], v[60:63]
    ds_read_b128 a[16:19], v8 offset:0
    v_mfma_f32_16x16x32_bf16 v[68:71], a[52:55], a[72:75], v[68:71]
    ds_read_b128 a[20:23], v8 offset:2048
    v_mfma_f32_16x16x32_bf16 v[64:67], a[48:51], a[72:75], v[64:67]
    ds_read_b128 a[24:27], v8 offset:10496
    buffer_load_dwordx4 v6, s[28:31], s55 offen offset:0  lds
    v_mfma_f32_16x16x32_bf16 v[72:75], a[72:75], a[56:59], v[72:75]
    ds_read_b128 a[28:31], v8 offset:12544
    v_mfma_f32_16x16x32_bf16 v[80:83], a[52:55], a[76:79], v[80:83]
    ds_read_b128 a[32:35], v8 offset:20992
    v_mfma_f32_16x16x32_bf16 v[76:79], a[48:51], a[76:79], v[76:79]
    ds_read_b128 a[36:39], v8 offset:23040
    v_mfma_f32_16x16x32_bf16 v[84:87], a[76:79], a[56:59], v[84:87]
    ds_read_b128 a[40:43], v8 offset:31488
    s_add_u32 m0, s56, 91136
    v_mfma_f32_16x16x32_bf16 v[92:95], a[52:55], a[80:83], v[92:95]
    ds_read_b128 a[44:47], v8 offset:33536
    buffer_load_dwordx4 v7, s[28:31], s55 offen offset:1024  lds
    v_mfma_f32_16x16x32_bf16 v[88:91], a[48:51], a[80:83], v[88:91]
    v_mfma_f32_16x16x32_bf16 v[96:99], a[80:83], a[56:59], v[96:99]
    v_mfma_f32_16x16x32_bf16 v[104:107], a[52:55], a[84:87], v[104:107]
    v_mfma_f32_16x16x32_bf16 v[100:103], a[48:51], a[84:87], v[100:103]
    buffer_load_dwordx4 v7, s[28:31], s55 offen offset:2048  lds
    v_mfma_f32_16x16x32_bf16 v[108:111], a[84:87], a[56:59], v[108:111]
    v_mfma_f32_16x16x32_bf16 v[116:119], a[52:55], a[88:91], v[116:119]
    v_mfma_f32_16x16x32_bf16 v[112:115], a[48:51], a[88:91], v[112:115]
    v_mfma_f32_16x16x32_bf16 v[120:123], a[88:91], a[56:59], v[120:123]
    v_mfma_f32_16x16x32_bf16 v[128:131], a[52:55], a[92:95], v[128:131]
    buffer_load_dwordx4 v7, s[28:31], s55 offen offset:0  lds
    v_mfma_f32_16x16x32_bf16 v[124:127], a[48:51], a[92:95], v[124:127]
    v_mfma_f32_16x16x32_bf16 v[132:135], a[92:95], a[56:59], v[132:135]
    s_waitcnt lgkmcnt(0)
    v_mfma_f32_16x16x32_bf16 v[32:35], a[4:7], a[12:15], v[32:35]
    ds_read_b64_tr_b16 a[52:53], v12 offset:22016
    v_mfma_f32_16x16x32_bf16 v[36:39], a[12:15], a[8:11], v[36:39]
    ds_read_b64_tr_b16 a[54:55], v12 offset:22528
    v_mfma_f32_16x16x32_bf16 v[44:47], a[4:7], a[16:19], v[44:47]
    ds_read_b64_tr_b16 a[56:57], v12 offset:23040
    buffer_load_dword v5, s[24:27], s54 offen offset:3072  lds
    v_mfma_f32_16x16x32_bf16 v[40:43], a[0:3], a[16:19], v[40:43]
    ds_read_b64_tr_b16 a[58:59], v12 offset:23552
    v_mfma_f32_16x16x32_bf16 v[48:51], a[16:19], a[8:11], v[48:51]
    ds_read_b128 a[60:63], v11
    v_mfma_f32_16x16x32_bf16 v[56:59], a[4:7], a[20:23], v[56:59]
    ds_read_b64_tr_b16 a[48:49], v12 offset:20992
    v_mfma_f32_16x16x32_bf16 v[52:55], a[0:3], a[20:23], v[52:55]
    ds_read_b64_tr_b16 a[50:51], v12 offset:21504
    s_add_u32 m0, s56, 83968
    v_mfma_f32_16x16x32_bf16 v[60:63], a[20:23], a[8:11], v[60:63]
    ds_read_b128 a[64:67], v9 offset:0
    buffer_load_dwordx4 v1, s[24:27], s54 offen offset:0  lds
    v_mfma_f32_16x16x32_bf16 v[68:71], a[4:7], a[24:27], v[68:71]
    ds_read_b128 a[68:71], v9 offset:2048
    v_mfma_f32_16x16x32_bf16 v[64:67], a[0:3], a[24:27], v[64:67]
    ds_read_b128 a[72:75], v9 offset:10496
    v_mfma_f32_16x16x32_bf16 v[72:75], a[24:27], a[8:11], v[72:75]
    ds_read_b128 a[76:79], v9 offset:12544
    v_mfma_f32_16x16x32_bf16 v[80:83], a[4:7], a[28:31], v[80:83]
    ds_read_b128 a[80:83], v9 offset:20992
    buffer_load_dwordx4 v2, s[24:27], s54 offen offset:1024  lds
    v_mfma_f32_16x16x32_bf16 v[76:79], a[0:3], a[28:31], v[76:79]
    ds_read_b128 a[84:87], v9 offset:23040
    v_mfma_f32_16x16x32_bf16 v[84:87], a[28:31], a[8:11], v[84:87]
    ds_read_b128 a[88:91], v9 offset:31488
    v_mfma_f32_16x16x32_bf16 v[92:95], a[4:7], a[32:35], v[92:95]
    ds_read_b128 a[92:95], v9 offset:33536
    v_mfma_f32_16x16x32_bf16 v[88:91], a[0:3], a[32:35], v[88:91]
    v_add_u32 v12, 0xa400, v12
    v_mfma_f32_16x16x32_bf16 v[96:99], a[32:35], a[8:11], v[96:99]
    v_add_u32 v10, 0xa400, v10
    buffer_load_dwordx4 v3, s[24:27], s54 offen offset:2048  lds
    v_mfma_f32_16x16x32_bf16 v[104:107], a[4:7], a[36:39], v[104:107]
    v_add_u32 v8, 0xa400, v8
    v_mfma_f32_16x16x32_bf16 v[100:103], a[0:3], a[36:39], v[100:103]
    v_add_u32 v11, 0xa400, v11
    v_mfma_f32_16x16x32_bf16 v[108:111], a[36:39], a[8:11], v[108:111]
    v_add_u32 v9, 0xa400, v9
    v_mfma_f32_16x16x32_bf16 v[116:119], a[4:7], a[40:43], v[116:119]
    v_mfma_f32_16x16x32_bf16 v[112:115], a[0:3], a[40:43], v[112:115]
    buffer_load_dwordx4 v4, s[24:27], s54 offen offset:3072  lds
    v_mfma_f32_16x16x32_bf16 v[120:123], a[40:43], a[8:11], v[120:123]
    v_mfma_f32_16x16x32_bf16 v[128:131], a[4:7], a[44:47], v[128:131]
    v_mfma_f32_16x16x32_bf16 v[124:127], a[0:3], a[44:47], v[124:127]
    v_mfma_f32_16x16x32_bf16 v[132:135], a[44:47], a[8:11], v[132:135]
    s_waitcnt vmcnt(11) lgkmcnt(0)
    s_barrier
    v_mfma_f32_16x16x32_bf16 v[32:35], a[52:55], a[60:63], v[32:35]
    ds_read_b64_tr_b16 a[4:5], v12 offset:1024
    s_xor_b32 s55, s3, 6
    v_mfma_f32_16x16x32_bf16 v[36:39], a[60:63], a[56:59], v[36:39]
    ds_read_b64_tr_b16 a[6:7], v12 offset:1536
    s_lshl_b32 s54, s55, 7
    v_mfma_f32_16x16x32_bf16 v[44:47], a[52:55], a[64:67], v[44:47]
    ds_read_b64_tr_b16 a[8:9], v12 offset:2048
    s_mul_i32 s55, s55, 196608
    v_mfma_f32_16x16x32_bf16 v[40:43], a[48:51], a[64:67], v[40:43]
    ds_read_b64_tr_b16 a[10:11], v12 offset:2560
    s_add_u32 m0, s56, 4096
    v_mfma_f32_16x16x32_bf16 v[48:51], a[64:67], a[56:59], v[48:51]
    ds_read_b128 a[12:15], v10
    buffer_load_dwordx4 v6, s[28:31], s55 offen offset:1024  lds
    v_mfma_f32_16x16x32_bf16 v[56:59], a[52:55], a[68:71], v[56:59]
    ds_read_b64_tr_b16 a[0:1], v12 offset:0
    buffer_load_dwordx4 v6, s[28:31], s55 offen offset:2048  lds
    v_mfma_f32_16x16x32_bf16 v[52:55], a[48:51], a[68:71], v[52:55]
    ds_read_b64_tr_b16 a[2:3], v12 offset:512
    v_mfma_f32_16x16x32_bf16 v[60:63], a[68:71], a[56:59], v[60:63]
    ds_read_b128 a[16:19], v8 offset:0
    v_mfma_f32_16x16x32_bf16 v[68:71], a[52:55], a[72:75], v[68:71]
    ds_read_b128 a[20:23], v8 offset:2048
    v_mfma_f32_16x16x32_bf16 v[64:67], a[48:51], a[72:75], v[64:67]
    ds_read_b128 a[24:27], v8 offset:10496
    buffer_load_dwordx4 v6, s[28:31], s55 offen offset:0  lds
    v_mfma_f32_16x16x32_bf16 v[72:75], a[72:75], a[56:59], v[72:75]
    ds_read_b128 a[28:31], v8 offset:12544
    v_mfma_f32_16x16x32_bf16 v[80:83], a[52:55], a[76:79], v[80:83]
    ds_read_b128 a[32:35], v8 offset:20992
    v_mfma_f32_16x16x32_bf16 v[76:79], a[48:51], a[76:79], v[76:79]
    ds_read_b128 a[36:39], v8 offset:23040
    v_mfma_f32_16x16x32_bf16 v[84:87], a[76:79], a[56:59], v[84:87]
    ds_read_b128 a[40:43], v8 offset:31488
    s_add_u32 m0, s56, 7168
    v_mfma_f32_16x16x32_bf16 v[92:95], a[52:55], a[80:83], v[92:95]
    ds_read_b128 a[44:47], v8 offset:33536
    buffer_load_dwordx4 v7, s[28:31], s55 offen offset:1024  lds
    v_mfma_f32_16x16x32_bf16 v[88:91], a[48:51], a[80:83], v[88:91]
    v_mfma_f32_16x16x32_bf16 v[96:99], a[80:83], a[56:59], v[96:99]
    v_mfma_f32_16x16x32_bf16 v[104:107], a[52:55], a[84:87], v[104:107]
    v_mfma_f32_16x16x32_bf16 v[100:103], a[48:51], a[84:87], v[100:103]
    buffer_load_dwordx4 v7, s[28:31], s55 offen offset:2048  lds
    v_mfma_f32_16x16x32_bf16 v[108:111], a[84:87], a[56:59], v[108:111]
    v_mfma_f32_16x16x32_bf16 v[116:119], a[52:55], a[88:91], v[116:119]
    v_mfma_f32_16x16x32_bf16 v[112:115], a[48:51], a[88:91], v[112:115]
    v_mfma_f32_16x16x32_bf16 v[120:123], a[88:91], a[56:59], v[120:123]
    v_mfma_f32_16x16x32_bf16 v[128:131], a[52:55], a[92:95], v[128:131]
    buffer_load_dwordx4 v7, s[28:31], s55 offen offset:0  lds
    v_mfma_f32_16x16x32_bf16 v[124:127], a[48:51], a[92:95], v[124:127]
    v_mfma_f32_16x16x32_bf16 v[132:135], a[92:95], a[56:59], v[132:135]
    s_waitcnt lgkmcnt(0)
    v_mfma_f32_16x16x32_bf16 v[32:35], a[4:7], a[12:15], v[32:35]
    ds_read_b64_tr_b16 a[52:53], v12 offset:22016
    v_mfma_f32_16x16x32_bf16 v[36:39], a[12:15], a[8:11], v[36:39]
    ds_read_b64_tr_b16 a[54:55], v12 offset:22528
    v_mfma_f32_16x16x32_bf16 v[44:47], a[4:7], a[16:19], v[44:47]
    ds_read_b64_tr_b16 a[56:57], v12 offset:23040
    buffer_load_dword v5, s[24:27], s54 offen offset:3072  lds
    v_mfma_f32_16x16x32_bf16 v[40:43], a[0:3], a[16:19], v[40:43]
    ds_read_b64_tr_b16 a[58:59], v12 offset:23552
    v_mfma_f32_16x16x32_bf16 v[48:51], a[16:19], a[8:11], v[48:51]
    ds_read_b128 a[60:63], v11
    v_mfma_f32_16x16x32_bf16 v[56:59], a[4:7], a[20:23], v[56:59]
    ds_read_b64_tr_b16 a[48:49], v12 offset:20992
    v_mfma_f32_16x16x32_bf16 v[52:55], a[0:3], a[20:23], v[52:55]
    ds_read_b64_tr_b16 a[50:51], v12 offset:21504
    s_add_u32 m0, s56, 0
    v_mfma_f32_16x16x32_bf16 v[60:63], a[20:23], a[8:11], v[60:63]
    ds_read_b128 a[64:67], v9 offset:0
    buffer_load_dwordx4 v1, s[24:27], s54 offen offset:0  lds
    v_mfma_f32_16x16x32_bf16 v[68:71], a[4:7], a[24:27], v[68:71]
    ds_read_b128 a[68:71], v9 offset:2048
    v_mfma_f32_16x16x32_bf16 v[64:67], a[0:3], a[24:27], v[64:67]
    ds_read_b128 a[72:75], v9 offset:10496
    v_mfma_f32_16x16x32_bf16 v[72:75], a[24:27], a[8:11], v[72:75]
    ds_read_b128 a[76:79], v9 offset:12544
    v_mfma_f32_16x16x32_bf16 v[80:83], a[4:7], a[28:31], v[80:83]
    ds_read_b128 a[80:83], v9 offset:20992
    buffer_load_dwordx4 v2, s[24:27], s54 offen offset:1024  lds
    v_mfma_f32_16x16x32_bf16 v[76:79], a[0:3], a[28:31], v[76:79]
    ds_read_b128 a[84:87], v9 offset:23040
    v_mfma_f32_16x16x32_bf16 v[84:87], a[28:31], a[8:11], v[84:87]
    ds_read_b128 a[88:91], v9 offset:31488
    v_mfma_f32_16x16x32_bf16 v[92:95], a[4:7], a[32:35], v[92:95]
    ds_read_b128 a[92:95], v9 offset:33536
    v_mfma_f32_16x16x32_bf16 v[88:91], a[0:3], a[32:35], v[88:91]
    v_add_u32 v12, 0xa400, v12
    v_mfma_f32_16x16x32_bf16 v[96:99], a[32:35], a[8:11], v[96:99]
    v_add_u32 v10, 0xa400, v10
    buffer_load_dwordx4 v3, s[24:27], s54 offen offset:2048  lds
    v_mfma_f32_16x16x32_bf16 v[104:107], a[4:7], a[36:39], v[104:107]
    v_add_u32 v8, 0xa400, v8
    v_mfma_f32_16x16x32_bf16 v[100:103], a[0:3], a[36:39], v[100:103]
    v_add_u32 v11, 0xa400, v11
    v_mfma_f32_16x16x32_bf16 v[108:111], a[36:39], a[8:11], v[108:111]
    v_add_u32 v9, 0xa400, v9
    v_mfma_f32_16x16x32_bf16 v[116:119], a[4:7], a[40:43], v[116:119]
    v_mfma_f32_16x16x32_bf16 v[112:115], a[0:3], a[40:43], v[112:115]
    buffer_load_dwordx4 v4, s[24:27], s54 offen offset:3072  lds
    v_mfma_f32_16x16x32_bf16 v[120:123], a[40:43], a[8:11], v[120:123]
    v_mfma_f32_16x16x32_bf16 v[128:131], a[4:7], a[44:47], v[128:131]
    v_mfma_f32_16x16x32_bf16 v[124:127], a[0:3], a[44:47], v[124:127]
    v_mfma_f32_16x16x32_bf16 v[132:135], a[44:47], a[8:11], v[132:135]
    s_waitcnt vmcnt(11) lgkmcnt(0)
    s_barrier
    v_mfma_f32_16x16x32_bf16 v[32:35], a[52:55], a[60:63], v[32:35]
    ds_read_b64_tr_b16 a[4:5], v12 offset:1024
    buffer_load_dword v252, off, s[44:47], s12 sc1
    v_mfma_f32_16x16x32_bf16 v[36:39], a[60:63], a[56:59], v[36:39]
    ds_read_b64_tr_b16 a[6:7], v12 offset:1536
    s_xor_b32 s55, s3, 7
    v_mfma_f32_16x16x32_bf16 v[44:47], a[52:55], a[64:67], v[44:47]
    ds_read_b64_tr_b16 a[8:9], v12 offset:2048
    s_lshl_b32 s54, s55, 7
    v_mfma_f32_16x16x32_bf16 v[40:43], a[48:51], a[64:67], v[40:43]
    ds_read_b64_tr_b16 a[10:11], v12 offset:2560
    s_mul_i32 s55, s55, 196608
    v_mfma_f32_16x16x32_bf16 v[48:51], a[64:67], a[56:59], v[48:51]
    ds_read_b128 a[12:15], v10
    s_add_u32 m0, s56, 46080
    v_mfma_f32_16x16x32_bf16 v[56:59], a[52:55], a[68:71], v[56:59]
    ds_read_b64_tr_b16 a[0:1], v12 offset:0
    buffer_load_dwordx4 v6, s[28:31], s55 offen offset:1024  lds
    v_mfma_f32_16x16x32_bf16 v[52:55], a[48:51], a[68:71], v[52:55]
    ds_read_b64_tr_b16 a[2:3], v12 offset:512
    v_mfma_f32_16x16x32_bf16 v[60:63], a[68:71], a[56:59], v[60:63]
    ds_read_b128 a[16:19], v8 offset:0
    v_mfma_f32_16x16x32_bf16 v[68:71], a[52:55], a[72:75], v[68:71]
    ds_read_b128 a[20:23], v8 offset:2048
    buffer_load_dwordx4 v6, s[28:31], s55 offen offset:2048  lds
    v_mfma_f32_16x16x32_bf16 v[64:67], a[48:51], a[72:75], v[64:67]
    ds_read_b128 a[24:27], v8 offset:10496
    v_mfma_f32_16x16x32_bf16 v[72:75], a[72:75], a[56:59], v[72:75]
    ds_read_b128 a[28:31], v8 offset:12544
    v_mfma_f32_16x16x32_bf16 v[80:83], a[52:55], a[76:79], v[80:83]
    ds_read_b128 a[32:35], v8 offset:20992
    v_mfma_f32_16x16x32_bf16 v[76:79], a[48:51], a[76:79], v[76:79]
    ds_read_b128 a[36:39], v8 offset:23040
    buffer_load_dwordx4 v6, s[28:31], s55 offen offset:0  lds
    v_mfma_f32_16x16x32_bf16 v[84:87], a[76:79], a[56:59], v[84:87]
    ds_read_b128 a[40:43], v8 offset:31488
    v_mfma_f32_16x16x32_bf16 v[92:95], a[52:55], a[80:83], v[92:95]
    ds_read_b128 a[44:47], v8 offset:33536
    v_mfma_f32_16x16x32_bf16 v[88:91], a[48:51], a[80:83], v[88:91]
    s_add_u32 m0, s56, 49152
    v_mfma_f32_16x16x32_bf16 v[96:99], a[80:83], a[56:59], v[96:99]
    buffer_load_dwordx4 v7, s[28:31], s55 offen offset:1024  lds
    v_mfma_f32_16x16x32_bf16 v[104:107], a[52:55], a[84:87], v[104:107]
    v_mfma_f32_16x16x32_bf16 v[100:103], a[48:51], a[84:87], v[100:103]
    v_mfma_f32_16x16x32_bf16 v[108:111], a[84:87], a[56:59], v[108:111]
    v_mfma_f32_16x16x32_bf16 v[116:119], a[52:55], a[88:91], v[116:119]
    buffer_load_dwordx4 v7, s[28:31], s55 offen offset:2048  lds
    v_mfma_f32_16x16x32_bf16 v[112:115], a[48:51], a[88:91], v[112:115]
    v_mfma_f32_16x16x32_bf16 v[120:123], a[88:91], a[56:59], v[120:123]
    v_mfma_f32_16x16x32_bf16 v[128:131], a[52:55], a[92:95], v[128:131]
    v_mfma_f32_16x16x32_bf16 v[124:127], a[48:51], a[92:95], v[124:127]
    buffer_load_dwordx4 v7, s[28:31], s55 offen offset:0  lds
    v_mfma_f32_16x16x32_bf16 v[132:135], a[92:95], a[56:59], v[132:135]
    s_waitcnt lgkmcnt(0)
    v_mfma_f32_16x16x32_bf16 v[32:35], a[4:7], a[12:15], v[32:35]
    ds_read_b64_tr_b16 a[52:53], v12 offset:22016
    v_mfma_f32_16x16x32_bf16 v[36:39], a[12:15], a[8:11], v[36:39]
    ds_read_b64_tr_b16 a[54:55], v12 offset:22528
    v_mfma_f32_16x16x32_bf16 v[44:47], a[4:7], a[16:19], v[44:47]
    ds_read_b64_tr_b16 a[56:57], v12 offset:23040
    buffer_load_dword v5, s[24:27], s54 offen offset:3072  lds
    v_mfma_f32_16x16x32_bf16 v[40:43], a[0:3], a[16:19], v[40:43]
    ds_read_b64_tr_b16 a[58:59], v12 offset:23552
    v_mfma_f32_16x16x32_bf16 v[48:51], a[16:19], a[8:11], v[48:51]
    ds_read_b128 a[60:63], v11
    v_mfma_f32_16x16x32_bf16 v[56:59], a[4:7], a[20:23], v[56:59]
    ds_read_b64_tr_b16 a[48:49], v12 offset:20992
    s_add_u32 m0, s56, 41984
    v_mfma_f32_16x16x32_bf16 v[52:55], a[0:3], a[20:23], v[52:55]
    ds_read_b64_tr_b16 a[50:51], v12 offset:21504
    buffer_load_dwordx4 v1, s[24:27], s54 offen offset:0  lds
    v_mfma_f32_16x16x32_bf16 v[60:63], a[20:23], a[8:11], v[60:63]
    ds_read_b128 a[64:67], v9 offset:0
    v_mfma_f32_16x16x32_bf16 v[68:71], a[4:7], a[24:27], v[68:71]
    ds_read_b128 a[68:71], v9 offset:2048
    v_mfma_f32_16x16x32_bf16 v[64:67], a[0:3], a[24:27], v[64:67]
    ds_read_b128 a[72:75], v9 offset:10496
    v_mfma_f32_16x16x32_bf16 v[72:75], a[24:27], a[8:11], v[72:75]
    ds_read_b128 a[76:79], v9 offset:12544
    buffer_load_dwordx4 v2, s[24:27], s54 offen offset:1024  lds
    v_mfma_f32_16x16x32_bf16 v[80:83], a[4:7], a[28:31], v[80:83]
    ds_read_b128 a[80:83], v9 offset:20992
    v_mfma_f32_16x16x32_bf16 v[76:79], a[0:3], a[28:31], v[76:79]
    ds_read_b128 a[84:87], v9 offset:23040
    v_mfma_f32_16x16x32_bf16 v[84:87], a[28:31], a[8:11], v[84:87]
    ds_read_b128 a[88:91], v9 offset:31488
    v_mfma_f32_16x16x32_bf16 v[92:95], a[4:7], a[32:35], v[92:95]
    ds_read_b128 a[92:95], v9 offset:33536
    buffer_load_dwordx4 v3, s[24:27], s54 offen offset:2048  lds
    v_mfma_f32_16x16x32_bf16 v[88:91], a[0:3], a[32:35], v[88:91]
    v_add_u32 v12, 0xfffeb800, v12
    v_mfma_f32_16x16x32_bf16 v[96:99], a[32:35], a[8:11], v[96:99]
    v_add_u32 v10, 0xfffeb800, v10
    v_mfma_f32_16x16x32_bf16 v[104:107], a[4:7], a[36:39], v[104:107]
    v_add_u32 v8, 0xfffeb800, v8
    v_mfma_f32_16x16x32_bf16 v[100:103], a[0:3], a[36:39], v[100:103]
    v_add_u32 v11, 0xfffeb800, v11
    buffer_load_dwordx4 v4, s[24:27], s54 offen offset:3072  lds
    v_mfma_f32_16x16x32_bf16 v[108:111], a[36:39], a[8:11], v[108:111]
    v_add_u32 v9, 0xfffeb800, v9
    v_mfma_f32_16x16x32_bf16 v[116:119], a[4:7], a[40:43], v[116:119]
    v_mfma_f32_16x16x32_bf16 v[112:115], a[0:3], a[40:43], v[112:115]
    v_mfma_f32_16x16x32_bf16 v[120:123], a[40:43], a[8:11], v[120:123]
    buffer_load_dword v14, v28, s[32:35], 0 offen
    v_mfma_f32_16x16x32_bf16 v[128:131], a[4:7], a[44:47], v[128:131]
    v_mfma_f32_16x16x32_bf16 v[124:127], a[0:3], a[44:47], v[124:127]
    v_mfma_f32_16x16x32_bf16 v[132:135], a[44:47], a[8:11], v[132:135]
    s_waitcnt vmcnt(13) lgkmcnt(0)
    s_barrier
    v_mfma_f32_16x16x32_bf16 v[32:35], a[52:55], a[60:63], v[32:35]
    ds_read_b64_tr_b16 a[4:5], v12 offset:1024
    s_add_u32 m0, s19, 125952
    v_mfma_f32_16x16x32_bf16 v[36:39], a[60:63], a[56:59], v[36:39]
    ds_read_b64_tr_b16 a[6:7], v12 offset:1536
    s_mov_b32 s55, 262144
    v_mfma_f32_16x16x32_bf16 v[44:47], a[52:55], a[64:67], v[44:47]
    ds_read_b64_tr_b16 a[8:9], v12 offset:2048
    buffer_load_dwordx4 v15, s[32:35], s55 offen offset:0  lds
    v_mfma_f32_16x16x32_bf16 v[40:43], a[48:51], a[64:67], v[40:43]
    ds_read_b64_tr_b16 a[10:11], v12 offset:2560
    v_mfma_f32_16x16x32_bf16 v[48:51], a[64:67], a[56:59], v[48:51]
    ds_read_b128 a[12:15], v10
    v_mfma_f32_16x16x32_bf16 v[56:59], a[52:55], a[68:71], v[56:59]
    ds_read_b64_tr_b16 a[0:1], v12 offset:0
    v_mfma_f32_16x16x32_bf16 v[52:55], a[48:51], a[68:71], v[52:55]
    ds_read_b64_tr_b16 a[2:3], v12 offset:512
    buffer_load_dwordx4 v16, s[32:35], s55 offen offset:1024  lds
    v_mfma_f32_16x16x32_bf16 v[60:63], a[68:71], a[56:59], v[60:63]
    ds_read_b128 a[16:19], v8 offset:0
    v_mfma_f32_16x16x32_bf16 v[68:71], a[52:55], a[72:75], v[68:71]
    ds_read_b128 a[20:23], v8 offset:2048
    v_mfma_f32_16x16x32_bf16 v[64:67], a[48:51], a[72:75], v[64:67]
    ds_read_b128 a[24:27], v8 offset:10496
    v_mfma_f32_16x16x32_bf16 v[72:75], a[72:75], a[56:59], v[72:75]
    ds_read_b128 a[28:31], v8 offset:12544
    v_mfma_f32_16x16x32_bf16 v[80:83], a[52:55], a[76:79], v[80:83]
    ds_read_b128 a[32:35], v8 offset:20992
    v_mfma_f32_16x16x32_bf16 v[76:79], a[48:51], a[76:79], v[76:79]
    ds_read_b128 a[36:39], v8 offset:23040
    v_mfma_f32_16x16x32_bf16 v[84:87], a[76:79], a[56:59], v[84:87]
    ds_read_b128 a[40:43], v8 offset:31488
    buffer_load_dwordx4 v17, s[32:35], s55 offen offset:2048  lds
    v_mfma_f32_16x16x32_bf16 v[92:95], a[52:55], a[80:83], v[92:95]
    ds_read_b128 a[44:47], v8 offset:33536
    v_mfma_f32_16x16x32_bf16 v[88:91], a[48:51], a[80:83], v[88:91]
    v_mfma_f32_16x16x32_bf16 v[96:99], a[80:83], a[56:59], v[96:99]
    v_mfma_f32_16x16x32_bf16 v[104:107], a[52:55], a[84:87], v[104:107]
    v_mfma_f32_16x16x32_bf16 v[100:103], a[48:51], a[84:87], v[100:103]
    v_mfma_f32_16x16x32_bf16 v[108:111], a[84:87], a[56:59], v[108:111]
    buffer_load_dwordx4 v18, s[32:35], s55 offen offset:3072  lds
    v_mfma_f32_16x16x32_bf16 v[116:119], a[52:55], a[88:91], v[116:119]
    v_mfma_f32_16x16x32_bf16 v[112:115], a[48:51], a[88:91], v[112:115]
    v_mfma_f32_16x16x32_bf16 v[120:123], a[88:91], a[56:59], v[120:123]
    v_mfma_f32_16x16x32_bf16 v[128:131], a[52:55], a[92:95], v[128:131]
    v_mfma_f32_16x16x32_bf16 v[124:127], a[48:51], a[92:95], v[124:127]
    s_add_u32 m0, s19, 130048
    v_mfma_f32_16x16x32_bf16 v[132:135], a[92:95], a[56:59], v[132:135]
    s_waitcnt lgkmcnt(0)
    s_mov_b32 s55, 294912
    v_mfma_f32_16x16x32_bf16 v[32:35], a[4:7], a[12:15], v[32:35]
    ds_read_b64_tr_b16 a[52:53], v12 offset:22016
    buffer_load_dwordx4 v15, s[32:35], s55 offen offset:0  lds
    v_mfma_f32_16x16x32_bf16 v[36:39], a[12:15], a[8:11], v[36:39]
    ds_read_b64_tr_b16 a[54:55], v12 offset:22528
    v_mfma_f32_16x16x32_bf16 v[44:47], a[4:7], a[16:19], v[44:47]
    ds_read_b64_tr_b16 a[56:57], v12 offset:23040
    v_mfma_f32_16x16x32_bf16 v[40:43], a[0:3], a[16:19], v[40:43]
    ds_read_b64_tr_b16 a[58:59], v12 offset:23552
    v_mfma_f32_16x16x32_bf16 v[48:51], a[16:19], a[8:11], v[48:51]
    ds_read_b128 a[60:63], v11
    v_mfma_f32_16x16x32_bf16 v[56:59], a[4:7], a[20:23], v[56:59]
    ds_read_b64_tr_b16 a[48:49], v12 offset:20992
    v_mfma_f32_16x16x32_bf16 v[52:55], a[0:3], a[20:23], v[52:55]
    ds_read_b64_tr_b16 a[50:51], v12 offset:21504
    buffer_load_dwordx4 v16, s[32:35], s55 offen offset:1024  lds
    v_mfma_f32_16x16x32_bf16 v[60:63], a[20:23], a[8:11], v[60:63]
    ds_read_b128 a[64:67], v9 offset:0
    v_mfma_f32_16x16x32_bf16 v[68:71], a[4:7], a[24:27], v[68:71]
    ds_read_b128 a[68:71], v9 offset:2048
    v_mfma_f32_16x16x32_bf16 v[64:67], a[0:3], a[24:27], v[64:67]
    ds_read_b128 a[72:75], v9 offset:10496
    v_mfma_f32_16x16x32_bf16 v[72:75], a[24:27], a[8:11], v[72:75]
    ds_read_b128 a[76:79], v9 offset:12544
    v_mfma_f32_16x16x32_bf16 v[80:83], a[4:7], a[28:31], v[80:83]
    ds_read_b128 a[80:83], v9 offset:20992
    v_mfma_f32_16x16x32_bf16 v[76:79], a[0:3], a[28:31], v[76:79]
    ds_read_b128 a[84:87], v9 offset:23040
    v_mfma_f32_16x16x32_bf16 v[84:87], a[28:31], a[8:11], v[84:87]
    ds_read_b128 a[88:91], v9 offset:31488
    buffer_load_dwordx4 v17, s[32:35], s55 offen offset:2048  lds
    v_mfma_f32_16x16x32_bf16 v[92:95], a[4:7], a[32:35], v[92:95]
    ds_read_b128 a[92:95], v9 offset:33536
    s_waitcnt vmcnt(19)
    v_readfirstlane_b32 s10, v252
    s_nop 0
    s_cmp_eq_u32 s10, s8
    s_cbranch_scc0 L_ros
L_rosback:
    v_mfma_f32_16x16x32_bf16 v[88:91], a[0:3], a[32:35], v[88:91]
    v_add_u32 v12, 0xa400, v12
    v_mfma_f32_16x16x32_bf16 v[96:99], a[32:35], a[8:11], v[96:99]
    v_add_u32 v10, 0xa400, v10
    v_mfma_f32_16x16x32_bf16 v[104:107], a[4:7], a[36:39], v[104:107]
    v_add_u32 v8, 0xa400, v8
    v_mfma_f32_16x16x32_bf16 v[100:103], a[0:3], a[36:39], v[100:103]
    v_add_u32 v11, 0xa400, v11
    v_mfma_f32_16x16x32_bf16 v[108:111], a[36:39], a[8:11], v[108:111]
    v_add_u32 v9, 0xa400, v9
    buffer_load_dwordx4 v18, s[32:35], s55 offen offset:3072  lds
    v_mfma_f32_16x16x32_bf16 v[116:119], a[4:7], a[40:43], v[116:119]
    v_mfma_f32_16x16x32_bf16 v[112:115], a[0:3], a[40:43], v[112:115]
    v_mfma_f32_16x16x32_bf16 v[120:123], a[40:43], a[8:11], v[120:123]
    v_mfma_f32_16x16x32_bf16 v[128:131], a[4:7], a[44:47], v[128:131]
    v_mfma_f32_16x16x32_bf16 v[124:127], a[0:3], a[44:47], v[124:127]
    v_mfma_f32_16x16x32_bf16 v[132:135], a[44:47], a[8:11], v[132:135]
    s_waitcnt vmcnt(9) lgkmcnt(0)
    s_barrier
    v_mfma_f32_16x16x32_bf16 v[32:35], a[52:55], a[60:63], v[32:35]
    ds_read_b64_tr_b16 a[4:5], v12 offset:1024
    ds_read_b64_tr_b16 a[6:7], v12 offset:1536
    v_mfma_f32_16x16x32_bf16 v[36:39], a[60:63], a[56:59], v[36:39]
    ds_read_b128 a[12:15], v10
    s_add_u32 m0, s19, 93184
    s_mov_b32 s55, 0
    buffer_load_dwordx4 v15, s[32:35], s55 offen offset:0  lds
    ds_read_b64_tr_b16 a[8:9], v12 offset:2048
    v_mfma_f32_16x16x32_bf16 v[44:47], a[52:55], a[64:67], v[44:47]
    ds_read_b64_tr_b16 a[10:11], v12 offset:2560
    ds_read_b64_tr_b16 a[100:101], v12 offset:22016
    v_mfma_f32_16x16x32_bf16 v[40:43], a[48:51], a[64:67], v[40:43]
    ds_read_b64_tr_b16 a[102:103], v12 offset:22528
    ds_read_b128 a[108:111], v11
    v_mfma_f32_16x16x32_bf16 v[48:51], a[64:67], a[56:59], v[48:51]
    ds_read_b64_tr_b16 a[104:105], v12 offset:23040
    buffer_load_dwordx4 v16, s[32:35], s55 offen offset:1024  lds
    ds_read_b64_tr_b16 a[106:107], v12 offset:23552
    v_mfma_f32_16x16x32_bf16 v[56:59], a[52:55], a[68:71], v[56:59]
    ds_read_b128 a[16:19], v8 offset:0
    ds_read_b64_tr_b16 a[0:1], v12 offset:0
    v_mfma_f32_16x16x32_bf16 v[52:55], a[48:51], a[68:71], v[52:55]
    ds_read_b64_tr_b16 a[2:3], v12 offset:512
    ds_read_b128 a[112:115], v9 offset:0
    v_mfma_f32_16x16x32_bf16 v[60:63], a[68:71], a[56:59], v[60:63]
    ds_read_b64_tr_b16 a[96:97], v12 offset:20992
    buffer_load_dwordx4 v17, s[32:35], s55 offen offset:2048  lds
    ds_read_b64_tr_b16 a[98:99], v12 offset:21504
    v_mfma_f32_16x16x32_bf16 v[68:71], a[52:55], a[72:75], v[68:71]
    ds_read_b128 a[20:23], v8 offset:2048
    ds_read_b128 a[116:119], v9 offset:2048
    v_mfma_f32_16x16x32_bf16 v[64:67], a[48:51], a[72:75], v[64:67]
    ds_read_b128 a[24:27], v8 offset:10496
    ds_read_b128 a[120:123], v9 offset:10496
    v_mfma_f32_16x16x32_bf16 v[72:75], a[72:75], a[56:59], v[72:75]
    ds_read_b128 a[28:31], v8 offset:12544
    buffer_load_dwordx4 v18, s[32:35], s55 offen offset:3072  lds
    ds_read_b128 a[124:127], v9 offset:12544
    s_waitcnt lgkmcnt(14)
    v_mfma_f32_16x16x32_bf16 v[32:35], a[4:7], a[12:15], v[32:35]
    ds_read_b128 a[32:35], v8 offset:20992
    ds_read_b128 a[128:131], v9 offset:20992
    v_mfma_f32_16x16x32_bf16 v[36:39], a[12:15], a[8:11], v[36:39]
    ds_read_b128 a[36:39], v8 offset:23040
    ds_read_b128 a[132:135], v9 offset:23040
    v_mfma_f32_16x16x32_bf16 v[32:35], a[100:103], a[108:111], v[32:35]
    s_add_u32 m0, s19, 97280
    s_mov_b32 s55, 32768
    buffer_load_dwordx4 v15, s[32:35], s55 offen offset:0  lds
    ds_read_b128 a[40:43], v8 offset:31488
    ds_read_b128 a[136:139], v9 offset:31488
    s_waitcnt lgkmcnt(14)
    v_mfma_f32_16x16x32_bf16 v[36:39], a[108:111], a[104:107], v[36:39]
    ds_read_b128 a[44:47], v8 offset:33536
    ds_read_b128 a[140:143], v9 offset:33536
    v_mfma_f32_16x16x32_bf16 v[44:47], a[4:7], a[16:19], v[44:47]
    v_cvt_pk_bf16_f32 v156, v32, v33
    v_mfma_f32_16x16x32_bf16 v[40:43], a[0:3], a[16:19], v[40:43]
    buffer_load_dwordx4 v16, s[32:35], s55 offen offset:1024  lds
    v_cvt_pk_bf16_f32 v157, v34, v35
    s_nop 0
    v_cvt_pk_bf16_f32 v174, v36, v37
    v_mfma_f32_16x16x32_bf16 v[44:47], a[100:103], a[112:115], v[44:47]
    v_cvt_pk_bf16_f32 v175, v38, v39
    s_waitcnt lgkmcnt(14)
    v_mfma_f32_16x16x32_bf16 v[40:43], a[96:99], a[112:115], v[40:43]
    v_mfma_f32_16x16x32_bf16 v[48:51], a[16:19], a[8:11], v[48:51]
    v_mfma_f32_16x16x32_bf16 v[48:51], a[112:115], a[104:107], v[48:51]
    s_waitcnt lgkmcnt(13)
    buffer_load_dwordx4 v17, s[32:35], s55 offen offset:2048  lds
    v_mfma_f32_16x16x32_bf16 v[56:59], a[4:7], a[20:23], v[56:59]
    v_mfma_f32_16x16x32_bf16 v[52:55], a[0:3], a[20:23], v[52:55]
    v_cvt_pk_bf16_f32 v158, v44, v45
    s_waitcnt lgkmcnt(12)
    v_mfma_f32_16x16x32_bf16 v[56:59], a[100:103], a[116:119], v[56:59]
    v_cvt_pk_bf16_f32 v159, v46, v47
    v_cvt_pk_bf16_f32 v192, v40, v41
    v_mfma_f32_16x16x32_bf16 v[52:55], a[96:99], a[116:119], v[52:55]
    v_cvt_pk_bf16_f32 v193, v42, v43
    buffer_load_dwordx4 v18, s[32:35], s55 offen offset:3072  lds
    v_cvt_pk_bf16_f32 v176, v48, v49
    v_mfma_f32_16x16x32_bf16 v[60:63], a[20:23], a[8:11], v[60:63]
    v_cvt_pk_bf16_f32 v177, v50, v51
    v_mfma_f32_16x16x16_bf16 v[40:43], v[158:159], v[192:193], v[136:139]
    v_cvt_pk_bf16_f32 v160, v56, v57
    v_cvt_pk_bf16_f32 v161, v58, v59
    v_mfma_f32_16x16x16_bf16 v[32:35], v[156:157], v[192:193], v[144:147]
    v_cvt_pk_bf16_f32 v194, v52, v53
    v_cvt_pk_bf16_f32 v195, v54, v55
    buffer_load_dword v14, v255, s[40:43], 0 offen
    v_mfma_f32_16x16x32_bf16 v[60:63], a[116:119], a[104:107], v[60:63]
    v_mfma_f32_16x16x16_bf16 v[52:55], v[160:161], v[194:195], v[136:139]
    v_mfma_f32_16x16x16_bf16 v[44:47], v[158:159], v[194:195], v[140:143]
    s_nop 1
    v_max_f32 v40, v40, v32
    s_waitcnt lgkmcnt(11)
    v_mfma_f32_16x16x32_bf16 v[68:71], a[4:7], a[24:27], v[68:71]
    v_max_f32 v41, v41, v33
    v_max_f32 v42, v42, v34
    v_mfma_f32_16x16x32_bf16 v[64:67], a[0:3], a[24:27], v[64:67]
    buffer_load_dword v14, v26, s[40:43], 0 offen sc1
    v_max_f32 v43, v43, v35
    v_max3_f32 v208, v40, v41, v42
    s_waitcnt lgkmcnt(10)
    v_mfma_f32_16x16x32_bf16 v[68:71], a[100:103], a[120:123], v[68:71]
    v_max_f32 v208, v208, v43
    v_max_f32 v52, v52, v44
    v_mfma_f32_16x16x32_bf16 v[64:67], a[96:99], a[120:123], v[64:67]
    v_max_f32 v53, v53, v45
    v_max_f32 v54, v54, v46
    v_mfma_f32_16x16x32_bf16 v[72:75], a[24:27], a[8:11], v[72:75]
    v_max_f32 v55, v55, v47
    v_max3_f32 v209, v52, v53, v54
    v_mfma_f32_16x16x32_bf16 v[72:75], a[120:123], a[104:107], v[72:75]
    v_max_f32 v209, v209, v55
    v_cvt_pk_bf16_f32 v178, v60, v61
    v_mfma_f32_16x16x32_bf16 v[80:83], a[52:55], a[76:79], v[80:83]
    v_permlane32_swap_b32 v208, v209
    v_max_f32 v216, v208, v209
    v_mfma_f32_16x16x32_bf16 v[76:79], a[48:51], a[76:79], v[76:79]
    v_max_f32 v209, v208, v209
    v_cvt_pk_bf16_f32 v179, v62, v63
    s_waitcnt lgkmcnt(9)
    v_mfma_f32_16x16x32_bf16 v[80:83], a[4:7], a[28:31], v[80:83]
    v_permlane16_swap_b32 v216, v209
    v_max_f32 v216, v216, v209
    v_mfma_f32_16x16x32_bf16 v[76:79], a[0:3], a[28:31], v[76:79]
    v_mul_f32 v208, s22, v216
    v_mul_f32 v209, s22, v216
    s_waitcnt lgkmcnt(8)
    v_mfma_f32_16x16x32_bf16 v[80:83], a[100:103], a[124:127], v[80:83]
    v_cvt_pk_bf16_f32 v162, v68, v69
    v_permlane32_swap_b32 v208, v209
    v_mfma_f32_16x16x32_bf16 v[76:79], a[96:99], a[124:127], v[76:79]
    v_fma_f32 v40, v40, s22, -v208
    v_fma_f32 v41, v41, s22, -v208
    v_mfma_f32_16x16x32_bf16 v[84:87], a[76:79], a[56:59], v[84:87]
    v_fma_f32 v42, v42, s22, -v208
    v_fma_f32 v43, v43, s22, -v208
    v_mfma_f32_16x16x32_bf16 v[84:87], a[28:31], a[8:11], v[84:87]
    v_fma_f32 v52, v52, s22, -v209
    v_fma_f32 v53, v53, s22, -v209
    v_mfma_f32_16x16x32_bf16 v[84:87], a[124:127], a[104:107], v[84:87]
    v_fma_f32 v54, v54, s22, -v209
    v_fma_f32 v55, v55, s22, -v209
    v_mfma_f32_16x16x32_bf16 v[92:95], a[52:55], a[80:83], v[92:95]
    v_exp_f32 v40, v40
    v_mfma_f32_16x16x32_bf16 v[88:91], a[48:51], a[80:83], v[88:91]
    v_exp_f32 v41, v41
    s_waitcnt lgkmcnt(7)
    v_mfma_f32_16x16x32_bf16 v[92:95], a[4:7], a[32:35], v[92:95]
    v_exp_f32 v42, v42
    v_mfma_f32_16x16x32_bf16 v[88:91], a[0:3], a[32:35], v[88:91]
    v_exp_f32 v43, v43
    s_waitcnt lgkmcnt(6)
    v_mfma_f32_16x16x32_bf16 v[92:95], a[100:103], a[128:131], v[92:95]
    v_exp_f32 v52, v52
    v_mfma_f32_16x16x32_bf16 v[88:91], a[96:99], a[128:131], v[88:91]
    v_exp_f32 v53, v53
    v_mfma_f32_16x16x32_bf16 v[96:99], a[80:83], a[56:59], v[96:99]
    v_exp_f32 v54, v54
    v_mfma_f32_16x16x32_bf16 v[96:99], a[32:35], a[8:11], v[96:99]
    v_exp_f32 v55, v55
    v_mfma_f32_16x16x32_bf16 v[96:99], a[128:131], a[104:107], v[96:99]
    v_cvt_pk_bf16_f32 v220, v40, v41
    v_cvt_pk_bf16_f32 v221, v42, v43
    v_mfma_f32_16x16x32_bf16 v[104:107], a[52:55], a[84:87], v[104:107]
    v_cvt_pk_bf16_f32 v222, v52, v53
    v_cvt_pk_bf16_f32 v223, v54, v55
    v_mfma_f32_16x16x16_bf16 v[40:43], v[152:153], v[220:221], 0
    v_and_b32 v32, v220, v150
    v_and_b32 v34, v220, v148
    v_mfma_f32_16x16x16_bf16 v[52:55], v[152:153], v[222:223], 0
    v_and_b32 v33, v221, v150
    v_and_b32 v35, v221, v148
    v_mfma_f32_16x16x32_bf16 v[100:103], a[48:51], a[84:87], v[100:103]
    v_and_b32 v44, v222, v150
    v_and_b32 v46, v222, v148
    v_mfma_f32_16x16x32_bf16 v[48:51], v[174:177], v[32:35], 0
    v_and_b32 v45, v223, v150
    v_and_b32 v47, v223, v148
    s_waitcnt lgkmcnt(5)
    v_mfma_f32_16x16x32_bf16 v[104:107], a[4:7], a[36:39], v[104:107]
    v_rcp_f32 v208, v40
    v_mfma_f32_16x16x32_bf16 v[60:63], v[176:179], v[44:47], 0
    v_rcp_f32 v209, v52
    v_mfma_f32_16x16x32_bf16 v[100:103], a[0:3], a[36:39], v[100:103]
    v_cvt_pk_bf16_f32 v163, v70, v71
    v_mul_f32 v48, v48, v208
    s_waitcnt lgkmcnt(4)
    v_mfma_f32_16x16x32_bf16 v[104:107], a[100:103], a[132:135], v[104:107]
    v_mul_f32 v49, v49, v208
    v_mul_f32 v50, v50, v208
    v_mfma_f32_16x16x32_bf16 v[100:103], a[96:99], a[132:135], v[100:103]
    v_mul_f32 v51, v51, v208
    v_mul_f32 v60, v60, v209
    v_mfma_f32_16x16x32_bf16 v[108:111], a[84:87], a[56:59], v[108:111]
    v_mul_f32 v61, v61, v209
    v_mul_f32 v62, v62, v209
    v_mfma_f32_16x16x32_bf16 v[108:111], a[36:39], a[8:11], v[108:111]
    v_mul_f32 v63, v63, v209
    v_cvt_pk_bf16_f32 v236, v48, v49
    v_mfma_f32_16x16x32_bf16 v[108:111], a[132:135], a[104:107], v[108:111]
    v_cvt_pk_bf16_f32 v237, v50, v51
    v_cvt_pk_bf16_f32 v238, v60, v61
    v_mfma_f32_16x16x32_bf16 v[116:119], a[52:55], a[88:91], v[116:119]
    v_cvt_pk_bf16_f32 v239, v62, v63
    v_permlane16_swap_b32 v236, v238
    v_mfma_f32_16x16x32_bf16 v[112:115], a[48:51], a[88:91], v[112:115]
    v_permlane16_swap_b32 v237, v239
    v_cvt_pk_bf16_f32 v196, v64, v65
    s_waitcnt lgkmcnt(3)
    v_mfma_f32_16x16x32_bf16 v[116:119], a[4:7], a[40:43], v[116:119]
    v_cvt_pk_bf16_f32 v197, v66, v67
    v_cvt_pk_bf16_f32 v180, v72, v73
    v_mfma_f32_16x16x32_bf16 v[112:115], a[0:3], a[40:43], v[112:115]
    v_cvt_pk_bf16_f32 v181, v74, v75
    v_cvt_pk_bf16_f32 v164, v80, v81
    v_mfma_f32_16x16x16_bf16 v[64:67], v[162:163], v[196:197], v[136:139]
    v_cvt_pk_bf16_f32 v165, v82, v83
    v_cvt_pk_bf16_f32 v198, v76, v77
    v_mfma_f32_16x16x16_bf16 v[56:59], v[160:161], v[196:197], v[140:143]
    v_cvt_pk_bf16_f32 v199, v78, v79
    v_cvt_pk_bf16_f32 v182, v84, v85
    s_waitcnt lgkmcnt(2)
    v_mfma_f32_16x16x32_bf16 v[116:119], a[100:103], a[136:139], v[116:119]
    v_cvt_pk_bf16_f32 v183, v86, v87
    v_cvt_pk_bf16_f32 v166, v92, v93
    v_mfma_f32_16x16x16_bf16 v[76:79], v[164:165], v[198:199], v[136:139]
    v_cvt_pk_bf16_f32 v167, v94, v95
    v_cvt_pk_bf16_f32 v200, v88, v89
    v_mfma_f32_16x16x16_bf16 v[68:71], v[162:163], v[198:199], v[140:143]
    v_max_f32 v64, v64, v56
    v_max_f32 v65, v65, v57
    v_mfma_f32_16x16x32_bf16 v[112:115], a[96:99], a[136:139], v[112:115]
    v_max_f32 v66, v66, v58
    v_max_f32 v67, v67, v59
    v_mfma_f32_16x16x32_bf16 v[120:123], a[88:91], a[56:59], v[120:123]
    v_max3_f32 v210, v64, v65, v66
    v_max_f32 v210, v210, v67
    v_mfma_f32_16x16x32_bf16 v[120:123], a[40:43], a[8:11], v[120:123]
    v_max_f32 v76, v76, v68
    v_max_f32 v77, v77, v69
    v_mfma_f32_16x16x32_bf16 v[120:123], a[136:139], a[104:107], v[120:123]
    v_max_f32 v78, v78, v70
    v_max_f32 v79, v79, v71
    v_mfma_f32_16x16x32_bf16 v[128:131], a[52:55], a[92:95], v[128:131]
    v_max3_f32 v211, v76, v77, v78
    v_max_f32 v211, v211, v79
    v_mfma_f32_16x16x32_bf16 v[124:127], a[48:51], a[92:95], v[124:127]
    v_cvt_pk_bf16_f32 v201, v90, v91
    v_permlane32_swap_b32 v210, v211
    s_waitcnt lgkmcnt(1)
    v_mfma_f32_16x16x32_bf16 v[128:131], a[4:7], a[44:47], v[128:131]
    v_max_f32 v217, v210, v211
    v_max_f32 v211, v210, v211
    v_mfma_f32_16x16x16_bf16 v[88:91], v[166:167], v[200:201], v[136:139]
    v_cvt_pk_bf16_f32 v184, v96, v97
    v_permlane16_swap_b32 v217, v211
    v_mfma_f32_16x16x16_bf16 v[80:83], v[164:165], v[200:201], v[140:143]
    v_max_f32 v217, v217, v211
    v_mul_f32 v210, s22, v217
    v_mfma_f32_16x16x32_bf16 v[124:127], a[0:3], a[44:47], v[124:127]
    v_mul_f32 v211, s22, v217
    v_cvt_pk_bf16_f32 v185, v98, v99
    s_waitcnt lgkmcnt(0)
    s_waitcnt vmcnt(2)
    s_barrier
    v_mfma_f32_16x16x32_bf16 v[128:131], a[100:103], a[140:143], v[128:131]
    v_permlane32_swap_b32 v210, v211
    v_fma_f32 v64, v64, s22, -v210
    v_mfma_f32_16x16x32_bf16 v[124:127], a[96:99], a[140:143], v[124:127]
    v_fma_f32 v65, v65, s22, -v210
    v_fma_f32 v66, v66, s22, -v210
    v_mfma_f32_16x16x32_bf16 v[132:135], a[92:95], a[56:59], v[132:135]
    v_fma_f32 v67, v67, s22, -v210
    v_fma_f32 v76, v76, s22, -v211
    v_mfma_f32_16x16x32_bf16 v[132:135], a[44:47], a[8:11], v[132:135]
    v_fma_f32 v77, v77, s22, -v211
    v_fma_f32 v78, v78, s22, -v211
    v_mfma_f32_16x16x32_bf16 v[132:135], a[140:143], a[104:107], v[132:135]
    v_fma_f32 v79, v79, s22, -v211
    v_exp_f32 v64, v64
    v_exp_f32 v65, v65
    v_exp_f32 v66, v66
    v_exp_f32 v67, v67
    v_exp_f32 v76, v76
    v_exp_f32 v77, v77
    v_exp_f32 v78, v78
    v_exp_f32 v79, v79
    v_cvt_pk_bf16_f32 v224, v64, v65
    v_cvt_pk_bf16_f32 v225, v66, v67
    v_cvt_pk_bf16_f32 v226, v76, v77
    v_cvt_pk_bf16_f32 v227, v78, v79
    v_mfma_f32_16x16x16_bf16 v[64:67], v[152:153], v[224:225], 0
    v_and_b32 v56, v224, v150
    v_and_b32 v58, v224, v148
    v_mfma_f32_16x16x16_bf16 v[76:79], v[152:153], v[226:227], 0
    v_and_b32 v57, v225, v150
    v_and_b32 v59, v225, v148
    v_and_b32 v68, v226, v150
    v_and_b32 v70, v226, v148
    v_mfma_f32_16x16x32_bf16 v[72:75], v[178:181], v[56:59], 0
    v_and_b32 v69, v227, v150
    v_and_b32 v71, v227, v148
    v_rcp_f32 v210, v64
    v_rcp_f32 v211, v76
    v_mfma_f32_16x16x32_bf16 v[84:87], v[180:183], v[68:71], 0
    v_max_f32 v88, v88, v80
    v_max_f32 v89, v89, v81
    v_max_f32 v90, v90, v82
    v_mul_f32 v72, v72, v210
    v_mul_f32 v73, v73, v210
    v_mul_f32 v74, v74, v210
    v_mul_f32 v75, v75, v210
    v_cvt_pk_bf16_f32 v240, v72, v73
    v_mul_f32 v84, v84, v211
    v_mul_f32 v85, v85, v211
    v_mul_f32 v86, v86, v211
    v_mul_f32 v87, v87, v211
    v_cvt_pk_bf16_f32 v241, v74, v75
    v_cvt_pk_bf16_f32 v242, v84, v85
    v_cvt_pk_bf16_f32 v243, v86, v87
    v_max_f32 v91, v91, v83
    v_permlane16_swap_b32 v240, v242
    v_permlane16_swap_b32 v241, v243
    s_cmp_eq_u32 s57, 0
    s_cbranch_scc1 L_slow0
    buffer_store_dwordx4 v[236:239], v23, s[40:43], 0 offen nt
    buffer_store_dwordx4 v[240:243], v23, s[40:43], s16 offen nt
L_join0:
    v_max3_f32 v212, v88, v89, v90
    v_max_f32 v212, v212, v91
    v_cvt_pk_bf16_f32 v168, v104, v105
    v_cvt_pk_bf16_f32 v169, v106, v107
    v_cvt_pk_bf16_f32 v202, v100, v101
    v_cvt_pk_bf16_f32 v203, v102, v103
    v_cvt_pk_bf16_f32 v186, v108, v109
    v_cvt_pk_bf16_f32 v187, v110, v111
    v_mfma_f32_16x16x16_bf16 v[100:103], v[168:169], v[202:203], v[136:139]
    v_cvt_pk_bf16_f32 v170, v116, v117
    v_cvt_pk_bf16_f32 v171, v118, v119
    v_mfma_f32_16x16x16_bf16 v[92:95], v[166:167], v[202:203], v[140:143]
    v_cvt_pk_bf16_f32 v204, v112, v113
    v_cvt_pk_bf16_f32 v205, v114, v115
    v_cvt_pk_bf16_f32 v188, v120, v121
    v_cvt_pk_bf16_f32 v189, v122, v123
    v_mfma_f32_16x16x16_bf16 v[112:115], v[170:171], v[204:205], v[136:139]
    v_cvt_pk_bf16_f32 v172, v128, v129
    v_cvt_pk_bf16_f32 v173, v130, v131
    v_mfma_f32_16x16x16_bf16 v[104:107], v[168:169], v[204:205], v[140:143]
    v_max_f32 v100, v100, v92
    v_max_f32 v101, v101, v93
    v_max_f32 v102, v102, v94
    v_max_f32 v103, v103, v95
    v_max3_f32 v213, v100, v101, v102
    v_max_f32 v213, v213, v103
    v_cvt_pk_bf16_f32 v206, v124, v125
    v_cvt_pk_bf16_f32 v207, v126, v127
    v_permlane32_swap_b32 v212, v213
    v_max_f32 v218, v212, v213
    v_mfma_f32_16x16x16_bf16 v[124:127], v[172:173], v[206:207], v[136:139]
    v_max_f32 v213, v212, v213
    v_max_f32 v112, v112, v104
    v_mfma_f32_16x16x16_bf16 v[116:119], v[170:171], v[206:207], v[140:143]
    v_permlane16_swap_b32 v218, v213
    v_max_f32 v218, v218, v213
    v_mul_f32 v212, s22, v218
    v_mul_f32 v213, s22, v218
    v_max_f32 v113, v113, v105
    v_max_f32 v114, v114, v106
    v_permlane32_swap_b32 v212, v213
    v_pk_fma_f32 v[88:89], v[88:89], s[22:23], v[212:213] op_sel:[0,0,0] op_sel_hi:[1,0,0] neg_lo:[0,0,1] neg_hi:[0,0,1]
    v_pk_fma_f32 v[90:91], v[90:91], s[22:23], v[212:213] op_sel:[0,0,0] op_sel_hi:[1,0,0] neg_lo:[0,0,1] neg_hi:[0,0,1]
    v_pk_fma_f32 v[100:101], v[100:101], s[22:23], v[212:213] op_sel:[0,0,1] op_sel_hi:[1,0,1] neg_lo:[0,0,1] neg_hi:[0,0,1]
    v_pk_fma_f32 v[102:103], v[102:103], s[22:23], v[212:213] op_sel:[0,0,1] op_sel_hi:[1,0,1] neg_lo:[0,0,1] neg_hi:[0,0,1]
    v_exp_f32 v88, v88
    v_exp_f32 v89, v89
    v_exp_f32 v90, v90
    v_exp_f32 v91, v91
    v_exp_f32 v100, v100
    v_exp_f32 v101, v101
    v_exp_f32 v102, v102
    v_exp_f32 v103, v103
    v_cvt_pk_bf16_f32 v228, v88, v89
    v_cvt_pk_bf16_f32 v229, v90, v91
    v_cvt_pk_bf16_f32 v230, v100, v101
    v_cvt_pk_bf16_f32 v231, v102, v103
    v_mfma_f32_16x16x16_bf16 v[88:91], v[152:153], v[228:229], 0
    v_and_b32 v80, v228, v150
    v_and_b32 v82, v228, v148
    v_mfma_f32_16x16x16_bf16 v[100:103], v[152:153], v[230:231], 0
    v_and_b32 v81, v229, v150
    v_and_b32 v83, v229, v148
    v_and_b32 v92, v230, v150
    v_and_b32 v94, v230, v148
    v_mfma_f32_16x16x32_bf16 v[96:99], v[182:185], v[80:83], 0
    v_and_b32 v93, v231, v150
    v_and_b32 v95, v231, v148
    v_rcp_f32 v212, v88
    v_rcp_f32 v213, v100
    s_waitcnt vmcnt(0)
    s_cmp_eq_u32 s57, 0
    s_cbranch_scc1 L_slow1
    buffer_store_dword v30, v27, s[40:43], 0 offen offset:0
L_join1:
    v_mfma_f32_16x16x32_bf16 v[108:111], v[184:187], v[92:95], 0
    v_max_f32 v115, v115, v107
    v_max3_f32 v214, v112, v113, v114
    v_max_f32 v214, v214, v115
    v_pk_mul_f32 v[96:97], v[96:97], v[212:213] op_sel:[0,0] op_sel_hi:[1,0]
    v_pk_mul_f32 v[98:99], v[98:99], v[212:213] op_sel:[0,0] op_sel_hi:[1,0]
    v_cvt_pk_bf16_f32 v244, v96, v97
    v_cvt_pk_bf16_f32 v245, v98, v99
    v_max_f32 v124, v124, v116
    v_pk_mul_f32 v[108:109], v[108:109], v[212:213] op_sel:[0,1] op_sel_hi:[1,1]
    v_pk_mul_f32 v[110:111], v[110:111], v[212:213] op_sel:[0,1] op_sel_hi:[1,1]
    v_cvt_pk_bf16_f32 v246, v108, v109
    v_cvt_pk_bf16_f32 v247, v110, v111
    v_max_f32 v125, v125, v117
    v_permlane16_swap_b32 v244, v246
    v_permlane16_swap_b32 v245, v247
    v_max_f32 v126, v126, v118
    v_max_f32 v127, v127, v119
    v_max3_f32 v215, v124, v125, v126
    v_max_f32 v215, v215, v127
    v_cvt_pk_bf16_f32 v190, v132, v133
    v_cvt_pk_bf16_f32 v191, v134, v135
    v_permlane32_swap_b32 v214, v215
    v_max_f32 v219, v214, v215
    v_max_f32 v215, v214, v215
    s_nop 1
    v_permlane16_swap_b32 v219, v215
    v_max_f32 v219, v219, v215
    v_mul_f32 v214, s22, v219
    v_mul_f32 v215, s22, v219
    s_nop 1
    v_permlane32_swap_b32 v214, v215
    v_pk_fma_f32 v[112:113], v[112:113], s[22:23], v[214:215] op_sel:[0,0,0] op_sel_hi:[1,0,0] neg_lo:[0,0,1] neg_hi:[0,0,1]
    buffer_load_dword v254, v26, s[40:43], 0 offen offset:0 sc1
    v_pk_fma_f32 v[114:115], v[114:115], s[22:23], v[214:215] op_sel:[0,0,0] op_sel_hi:[1,0,0] neg_lo:[0,0,1] neg_hi:[0,0,1]
    v_pk_fma_f32 v[124:125], v[124:125], s[22:23], v[214:215] op_sel:[0,0,1] op_sel_hi:[1,0,1] neg_lo:[0,0,1] neg_hi:[0,0,1]
    v_pk_fma_f32 v[126:127], v[126:127], s[22:23], v[214:215] op_sel:[0,0,1] op_sel_hi:[1,0,1] neg_lo:[0,0,1] neg_hi:[0,0,1]
    v_exp_f32 v112, v112
    v_exp_f32 v113, v113
    v_exp_f32 v114, v114
    v_exp_f32 v115, v115
    v_exp_f32 v124, v124
    v_exp_f32 v125, v125
    v_exp_f32 v126, v126
    v_exp_f32 v127, v127
    v_cvt_pk_bf16_f32 v232, v112, v113
    v_cvt_pk_bf16_f32 v233, v114, v115
    v_cvt_pk_bf16_f32 v234, v124, v125
    v_cvt_pk_bf16_f32 v235, v126, v127
    v_mfma_f32_16x16x16_bf16 v[112:115], v[152:153], v[232:233], 0
    v_and_b32 v104, v232, v150
    v_and_b32 v106, v232, v148
    v_mfma_f32_16x16x16_bf16 v[124:127], v[152:153], v[234:235], 0
    buffer_load_dword v253, v26, s[40:43], 0 offen offset:0 sc1
    v_and_b32 v105, v233, v150
    v_and_b32 v107, v233, v148
    v_and_b32 v116, v234, v150
    v_and_b32 v118, v234, v148
    v_mfma_f32_16x16x32_bf16 v[120:123], v[186:189], v[104:107], 0
    v_and_b32 v117, v235, v150
    v_and_b32 v119, v235, v148
    v_rcp_f32 v214, v112
    v_rcp_f32 v215, v124
    v_mfma_f32_16x16x32_bf16 v[132:135], v[188:191], v[116:119], 0
    s_nop 2
    v_pk_mul_f32 v[120:121], v[120:121], v[214:215] op_sel:[0,0] op_sel_hi:[1,0]
    v_pk_mul_f32 v[122:123], v[122:123], v[214:215] op_sel:[0,0] op_sel_hi:[1,0]
    v_cvt_pk_bf16_f32 v248, v120, v121
    v_cvt_pk_bf16_f32 v249, v122, v123
    s_nop 0
    v_pk_mul_f32 v[132:133], v[132:133], v[214:215] op_sel:[0,1] op_sel_hi:[1,1]
    v_pk_mul_f32 v[134:135], v[134:135], v[214:215] op_sel:[0,1] op_sel_hi:[1,1]
    v_cvt_pk_bf16_f32 v250, v132, v133
    v_cvt_pk_bf16_f32 v251, v134, v135
    s_nop 0
    v_permlane16_swap_b32 v248, v250
    v_permlane16_swap_b32 v249, v251
    buffer_load_dword v255, v26, s[40:43], 0 offen offset:0 sc1
    s_cmp_eq_u32 s57, 0
    s_cbranch_scc1 L_slow2
    buffer_store_dwordx4 v[244:247], v23, s[40:43], s17 offen nt
    buffer_store_dwordx4 v[248:251], v23, s[40:43], s18 offen nt
L_join2:
    ds_read_b64_tr_b16 a[144:145], v19 offset:0
    ds_read_b64_tr_b16 a[146:147], v19 offset:512
    ds_read_b64_tr_b16 a[148:149], v20 offset:0
    ds_read_b64_tr_b16 a[150:151], v20 offset:512
    ds_read_b64_tr_b16 a[152:153], v21 offset:0
    ds_read_b64_tr_b16 a[154:155], v21 offset:512
    ds_read_b64_tr_b16 a[156:157], v22 offset:0
    ds_read_b64_tr_b16 a[158:159], v22 offset:512
    ds_read_b64_tr_b16 a[160:161], v19 offset:4096
    ds_read_b64_tr_b16 a[162:163], v19 offset:4608
    ds_read_b64_tr_b16 a[164:165], v20 offset:4096
    ds_read_b64_tr_b16 a[166:167], v20 offset:4608
    ds_read_b64_tr_b16 a[168:169], v21 offset:4096
    ds_read_b64_tr_b16 a[170:171], v21 offset:4608
    ds_read_b64_tr_b16 a[172:173], v22 offset:4096
    ds_read_b64_tr_b16 a[174:175], v22 offset:4608
    s_waitcnt vmcnt(4)
    v_cmp_eq_u32 vcc, s8, v254
    s_nop 0
    s_cmp_eq_u64 vcc, -1
    s_cbranch_scc0 L_spin0
L_got0:
    s_mov_b32 s63, 0x40000
    buffer_load_dwordx4 v[32:35], v24, s[40:43], 0 offen offset:0 sc1
    ds_read_b64_tr_b16 a[176:177], v19 offset:8192
    ds_read_b64_tr_b16 a[178:179], v19 offset:8704
    ds_read_b64_tr_b16 a[180:181], v20 offset:8192
    ds_read_b64_tr_b16 a[182:183], v20 offset:8704
    ds_read_b64_tr_b16 a[184:185], v21 offset:8192
    ds_read_b64_tr_b16 a[186:187], v21 offset:8704
    ds_read_b64_tr_b16 a[188:189], v22 offset:8192
    buffer_load_dwordx4 v[36:39], v24, s[40:43], 0 offen offset:1024 sc1
    ds_read_b64_tr_b16 a[190:191], v22 offset:8704
    ds_read_b64_tr_b16 a[192:193], v19 offset:12288
    ds_read_b64_tr_b16 a[194:195], v19 offset:12800
    ds_read_b64_tr_b16 a[196:197], v20 offset:12288
    ds_read_b64_tr_b16 a[198:199], v20 offset:12800
    ds_read_b64_tr_b16 a[200:201], v21 offset:12288
    ds_read_b64_tr_b16 a[202:203], v21 offset:12800
    buffer_load_dwordx4 v[40:43], v24, s[40:43], 0 offen offset:2048 sc1
    ds_read_b64_tr_b16 a[204:205], v22 offset:12288
    ds_read_b64_tr_b16 a[206:207], v22 offset:12800
    ds_read_b64_tr_b16 a[208:209], v19 offset:16384
    ds_read_b64_tr_b16 a[210:211], v19 offset:16896
    ds_read_b64_tr_b16 a[212:213], v20 offset:16384
    ds_read_b64_tr_b16 a[214:215], v20 offset:16896
    ds_read_b64_tr_b16 a[216:217], v21 offset:16384
    buffer_load_dwordx4 v[44:47], v24, s[40:43], 0 offen offset:3072 sc1
    ds_read_b64_tr_b16 a[218:219], v21 offset:16896
    ds_read_b64_tr_b16 a[220:221], v22 offset:16384
    ds_read_b64_tr_b16 a[222:223], v22 offset:16896
    ds_read_b64_tr_b16 a[224:225], v19 offset:20480
    ds_read_b64_tr_b16 a[226:227], v19 offset:20992
    ds_read_b64_tr_b16 a[228:229], v20 offset:20480
    ds_read_b64_tr_b16 a[230:231], v20 offset:20992
    buffer_load_dwordx4 v[48:51], v24, s[40:43], s13 offen offset:0 sc1
    s_waitcnt vmcnt(5)
    s_cmp_eq_u32 s57, 0
    s_cbranch_scc1 L_slow3
    buffer_store_dword v30, v27, s[40:43], 0 offen offset:16
L_join3:
    ds_read_b64_tr_b16 a[232:233], v21 offset:20480
    ds_read_b64_tr_b16 a[234:235], v21 offset:20992
    ds_read_b64_tr_b16 a[236:237], v22 offset:20480
    ds_read_b64_tr_b16 a[238:239], v22 offset:20992
    s_mul_i32 s60, s48, 2304
    v_and_b32 v10, 15, v0
    v_lshrrev_b32 v11, 4, v0
    v_mul_u32_u24 v10, 144, v10
    v_lshl_add_u32 v10, v11, 3, v10
    v_add_u32 v8, s60, v10
    v_and_b32 v10, 7, v0
    v_lshrrev_b32 v11, 3, v0
    v_mul_u32_u24 v11, 144, v11
    v_lshl_add_u32 v10, v10, 4, v11
    v_add_u32 v9, s60, v10
    s_mov_b32 s61, 0x8000
    s_mov_b32 s62, 0x48000
    s_waitcnt vmcnt(5)
    s_waitcnt lgkmcnt(14)
    v_mfma_f32_16x16x32_bf16 v[156:159], a[144:147], v[32:35], 0
    buffer_load_dwordx4 v[52:55], v24, s[40:43], s13 offen offset:1024 sc1
    ds_read_b64_tr_b16 a[240:241], v19 offset:24576
    ds_read_b64_tr_b16 a[242:243], v19 offset:25088
    v_mfma_f32_16x16x32_bf16 v[160:163], a[148:151], v[32:35], 0
    ds_read_b64_tr_b16 a[244:245], v20 offset:24576
    ds_read_b64_tr_b16 a[246:247], v20 offset:25088
    v_mfma_f32_16x16x32_bf16 v[164:167], a[152:155], v[32:35], 0
    ds_read_b64_tr_b16 a[248:249], v21 offset:24576
    ds_read_b64_tr_b16 a[250:251], v21 offset:25088
    v_mfma_f32_16x16x32_bf16 v[168:171], a[156:159], v[32:35], 0
    ds_read_b64_tr_b16 a[252:253], v22 offset:24576
    ds_read_b64_tr_b16 a[254:255], v22 offset:25088
    s_waitcnt vmcnt(5)
    v_mfma_f32_16x16x32_bf16 v[156:159], a[160:163], v[36:39], v[156:159]
    buffer_load_dwordx4 v[56:59], v24, s[40:43], s13 offen offset:2048 sc1
    ds_read_b64_tr_b16 a[0:1], v19 offset:28672
    ds_read_b64_tr_b16 a[2:3], v19 offset:29184
    v_mfma_f32_16x16x32_bf16 v[160:163], a[164:167], v[36:39], v[160:163]
    ds_read_b64_tr_b16 a[4:5], v20 offset:28672
    ds_read_b64_tr_b16 a[6:7], v20 offset:29184
    v_mfma_f32_16x16x32_bf16 v[164:167], a[168:171], v[36:39], v[164:167]
    ds_read_b64_tr_b16 a[8:9], v21 offset:28672
    ds_read_b64_tr_b16 a[10:11], v21 offset:29184
    v_mfma_f32_16x16x32_bf16 v[168:171], a[172:175], v[36:39], v[168:171]
    ds_read_b64_tr_b16 a[12:13], v22 offset:28672
    ds_read_b64_tr_b16 a[14:15], v22 offset:29184
    s_waitcnt vmcnt(5)
    v_mfma_f32_16x16x32_bf16 v[156:159], a[176:179], v[40:43], v[156:159]
    buffer_load_dwordx4 v[60:63], v24, s[40:43], s13 offen offset:3072 sc1
    ds_read_b64_tr_b16 a[16:17], v19 offset:32768
    ds_read_b64_tr_b16 a[18:19], v19 offset:33280
    v_mfma_f32_16x16x32_bf16 v[160:163], a[180:183], v[40:43], v[160:163]
    ds_read_b64_tr_b16 a[20:21], v20 offset:32768
    ds_read_b64_tr_b16 a[22:23], v20 offset:33280
    v_mfma_f32_16x16x32_bf16 v[164:167], a[184:187], v[40:43], v[164:167]
    ds_read_b64_tr_b16 a[24:25], v21 offset:32768
    ds_read_b64_tr_b16 a[26:27], v21 offset:33280
    v_mfma_f32_16x16x32_bf16 v[168:171], a[188:191], v[40:43], v[168:171]
    ds_read_b64_tr_b16 a[28:29], v22 offset:32768
    ds_read_b64_tr_b16 a[30:31], v22 offset:33280
    s_waitcnt vmcnt(5)
    v_mfma_f32_16x16x32_bf16 v[156:159], a[192:195], v[44:47], v[156:159]
    buffer_load_dwordx4 v[64:67], v24, s[40:43], s14 offen offset:0 sc1
    ds_read_b64_tr_b16 a[32:33], v19 offset:36864
    ds_read_b64_tr_b16 a[34:35], v19 offset:37376
    v_mfma_f32_16x16x32_bf16 v[160:163], a[196:199], v[44:47], v[160:163]
    ds_read_b64_tr_b16 a[36:37], v20 offset:36864
    ds_read_b64_tr_b16 a[38:39], v20 offset:37376
    v_mfma_f32_16x16x32_bf16 v[164:167], a[200:203], v[44:47], v[164:167]
    ds_read_b64_tr_b16 a[40:41], v21 offset:36864
    ds_read_b64_tr_b16 a[42:43], v21 offset:37376
    v_mfma_f32_16x16x32_bf16 v[168:171], a[204:207], v[44:47], v[168:171]
    ds_read_b64_tr_b16 a[44:45], v22 offset:36864
    ds_read_b64_tr_b16 a[46:47], v22 offset:37376
    s_waitcnt vmcnt(5)
    v_mfma_f32_16x16x32_bf16 v[156:159], a[208:211], v[48:51], v[156:159]
    buffer_load_dwordx4 v[68:71], v24, s[40:43], s14 offen offset:1024 sc1
    ds_read_b64_tr_b16 a[48:49], v19 offset:40960
    ds_read_b64_tr_b16 a[50:51], v19 offset:41472
    s_waitcnt lgkmcnt(14)
    v_mfma_f32_16x16x32_bf16 v[160:163], a[212:215], v[48:51], v[160:163]
    ds_read_b64_tr_b16 a[52:53], v20 offset:40960
    ds_read_b64_tr_b16 a[54:55], v20 offset:41472
    v_mfma_f32_16x16x32_bf16 v[164:167], a[216:219], v[48:51], v[164:167]
    ds_read_b64_tr_b16 a[56:57], v21 offset:40960
    ds_read_b64_tr_b16 a[58:59], v21 offset:41472
    v_mfma_f32_16x16x32_bf16 v[168:171], a[220:223], v[48:51], v[168:171]
    ds_read_b64_tr_b16 a[60:61], v22 offset:40960
    ds_read_b64_tr_b16 a[62:63], v22 offset:41472
    s_waitcnt vmcnt(4)
    v_mfma_f32_16x16x32_bf16 v[156:159], a[224:227], v[52:55], v[156:159]
    buffer_load_dwordx4 v[72:75], v24, s[40:43], s14 offen offset:2048 sc1
    buffer_load_dword v254, v26, s[40:43], 0 offen offset:16 sc1
    ds_read_b64_tr_b16 a[64:65], v19 offset:45056
    ds_read_b64_tr_b16 a[66:67], v19 offset:45568
    v_mfma_f32_16x16x32_bf16 v[160:163], a[228:231], v[52:55], v[160:163]
    ds_read_b64_tr_b16 a[68:69], v20 offset:45056
    ds_read_b64_tr_b16 a[70:71], v20 offset:45568
    v_mfma_f32_16x16x32_bf16 v[164:167], a[232:235], v[52:55], v[164:167]
    ds_read_b64_tr_b16 a[72:73], v21 offset:45056
    ds_read_b64_tr_b16 a[74:75], v21 offset:45568
    v_mfma_f32_16x16x32_bf16 v[168:171], a[236:239], v[52:55], v[168:171]
    ds_read_b64_tr_b16 a[76:77], v22 offset:45056
    ds_read_b64_tr_b16 a[78:79], v22 offset:45568
    s_waitcnt vmcnt(5)
    v_mfma_f32_16x16x32_bf16 v[156:159], a[240:243], v[56:59], v[156:159]
    buffer_load_dwordx4 v[76:79], v24, s[40:43], s14 offen offset:3072 sc1
    ds_read_b64_tr_b16 a[80:81], v19 offset:49152
    ds_read_b64_tr_b16 a[82:83], v19 offset:49664
    v_mfma_f32_16x16x32_bf16 v[160:163], a[244:247], v[56:59], v[160:163]
    ds_read_b64_tr_b16 a[84:85], v20 offset:49152
    ds_read_b64_tr_b16 a[86:87], v20 offset:49664
    v_mfma_f32_16x16x32_bf16 v[164:167], a[248:251], v[56:59], v[164:167]
    ds_read_b64_tr_b16 a[88:89], v21 offset:49152
    ds_read_b64_tr_b16 a[90:91], v21 offset:49664
    v_mfma_f32_16x16x32_bf16 v[168:171], a[252:255], v[56:59], v[168:171]
    ds_read_b64_tr_b16 a[92:93], v22 offset:49152
    ds_read_b64_tr_b16 a[94:95], v22 offset:49664
    s_waitcnt vmcnt(5)
    v_mfma_f32_16x16x32_bf16 v[156:159], a[0:3], v[60:63], v[156:159]
    buffer_load_dwordx4 v[84:87], v24, s[40:43], s15 offen offset:0 sc1
    ds_read_b64_tr_b16 a[96:97], v19 offset:53248
    ds_read_b64_tr_b16 a[98:99], v19 offset:53760
    v_mfma_f32_16x16x32_bf16 v[160:163], a[4:7], v[60:63], v[160:163]
    ds_read_b64_tr_b16 a[100:101], v20 offset:53248
    ds_read_b64_tr_b16 a[102:103], v20 offset:53760
    v_mfma_f32_16x16x32_bf16 v[164:167], a[8:11], v[60:63], v[164:167]
    ds_read_b64_tr_b16 a[104:105], v21 offset:53248
    ds_read_b64_tr_b16 a[106:107], v21 offset:53760
    v_mfma_f32_16x16x32_bf16 v[168:171], a[12:15], v[60:63], v[168:171]
    ds_read_b64_tr_b16 a[108:109], v22 offset:53248
    ds_read_b64_tr_b16 a[110:111], v22 offset:53760
    s_waitcnt vmcnt(5)
    v_mfma_f32_16x16x32_bf16 v[156:159], a[16:19], v[64:67], v[156:159]
    buffer_load_dwordx4 v[192:195], v24, s[40:43], s15 offen offset:1024 sc1
    ds_read_b64_tr_b16 a[112:113], v19 offset:57344
    ds_read_b64_tr_b16 a[114:115], v19 offset:57856
    v_mfma_f32_16x16x32_bf16 v[160:163], a[20:23], v[64:67], v[160:163]
    ds_read_b64_tr_b16 a[116:117], v20 offset:57344
    ds_read_b64_tr_b16 a[118:119], v20 offset:57856
    s_waitcnt lgkmcnt(14)
    v_mfma_f32_16x16x32_bf16 v[164:167], a[24:27], v[64:67], v[164:167]
    ds_read_b64_tr_b16 a[120:121], v21 offset:57344
    ds_read_b64_tr_b16 a[122:123], v21 offset:57856
    v_mfma_f32_16x16x32_bf16 v[168:171], a[28:31], v[64:67], v[168:171]
    ds_read_b64_tr_b16 a[124:125], v22 offset:57344
    ds_read_b64_tr_b16 a[126:127], v22 offset:57856
    s_waitcnt vmcnt(5)
    v_mfma_f32_16x16x32_bf16 v[156:159], a[32:35], v[68:71], v[156:159]
    buffer_load_dwordx4 v[196:199], v24, s[40:43], s15 offen offset:2048 sc1
    ds_read_b64_tr_b16 a[128:129], v19 offset:61440
    ds_read_b64_tr_b16 a[130:131], v19 offset:61952
    v_mfma_f32_16x16x32_bf16 v[160:163], a[36:39], v[68:71], v[160:163]
    ds_read_b64_tr_b16 a[132:133], v20 offset:61440
    ds_read_b64_tr_b16 a[134:135], v20 offset:61952
    v_mfma_f32_16x16x32_bf16 v[164:167], a[40:43], v[68:71], v[164:167]
    ds_read_b64_tr_b16 a[136:137], v21 offset:61440
    ds_read_b64_tr_b16 a[138:139], v21 offset:61952
    v_mfma_f32_16x16x32_bf16 v[168:171], a[44:47], v[68:71], v[168:171]
    ds_read_b64_tr_b16 a[140:141], v22 offset:61440
    ds_read_b64_tr_b16 a[142:143], v22 offset:61952
    s_waitcnt vmcnt(5)
    v_mfma_f32_16x16x32_bf16 v[156:159], a[48:51], v[72:75], v[156:159]
    buffer_load_dwordx4 v[80:83], v24, s[40:43], s15 offen offset:3072 sc1
    v_add_u32 v24, 65536, v24
    v_mfma_f32_16x16x32_bf16 v[160:163], a[52:55], v[72:75], v[160:163]
    v_mfma_f32_16x16x32_bf16 v[164:167], a[56:59], v[72:75], v[164:167]
    v_mfma_f32_16x16x32_bf16 v[168:171], a[60:63], v[72:75], v[168:171]
    s_waitcnt vmcnt(5)
    v_cmp_eq_u32 vcc, s8, v254
    s_nop 0
    s_cmp_eq_u64 vcc, -1
    s_cbranch_scc0 L_spin1
L_got1:
    buffer_load_dwordx4 v[88:91], v24, s[40:43], 0 offen offset:0 sc1
    buffer_load_dwordx4 v[92:95], v24, s[40:43], 0 offen offset:1024 sc1
    s_waitcnt vmcnt(6)
    v_mfma_f32_16x16x32_bf16 v[156:159], a[64:67], v[76:79], v[156:159]
    buffer_load_dwordx4 v[96:99], v24, s[40:43], 0 offen offset:2048 sc1
    v_mfma_f32_16x16x32_bf16 v[160:163], a[68:71], v[76:79], v[160:163]
    v_mfma_f32_16x16x32_bf16 v[164:167], a[72:75], v[76:79], v[164:167]
    v_mfma_f32_16x16x32_bf16 v[168:171], a[76:79], v[76:79], v[168:171]
    s_waitcnt vmcnt(6)
    v_mfma_f32_16x16x32_bf16 v[156:159], a[80:83], v[84:87], v[156:159]
    buffer_load_dwordx4 v[100:103], v24, s[40:43], 0 offen offset:3072 sc1
    v_mfma_f32_16x16x32_bf16 v[160:163], a[84:87], v[84:87], v[160:163]
    v_mfma_f32_16x16x32_bf16 v[164:167], a[88:91], v[84:87], v[164:167]
    s_waitcnt lgkmcnt(14)
    v_mfma_f32_16x16x32_bf16 v[168:171], a[92:95], v[84:87], v[168:171]
    s_waitcnt vmcnt(6)
    v_mfma_f32_16x16x32_bf16 v[156:159], a[96:99], v[192:195], v[156:159]
    buffer_load_dwordx4 v[104:107], v24, s[40:43], s13 offen offset:0 sc1
    v_mfma_f32_16x16x32_bf16 v[160:163], a[100:103], v[192:195], v[160:163]
    v_mfma_f32_16x16x32_bf16 v[164:167], a[104:107], v[192:195], v[164:167]
    v_mfma_f32_16x16x32_bf16 v[168:171], a[108:111], v[192:195], v[168:171]
    s_waitcnt vmcnt(6)
    v_mfma_f32_16x16x32_bf16 v[156:159], a[112:115], v[196:199], v[156:159]
    buffer_load_dwordx4 v[108:111], v24, s[40:43], s13 offen offset:1024 sc1
    s_waitcnt lgkmcnt(12)
    v_mfma_f32_16x16x32_bf16 v[160:163], a[116:119], v[196:199], v[160:163]
    s_waitcnt lgkmcnt(10)
    v_mfma_f32_16x16x32_bf16 v[164:167], a[120:123], v[196:199], v[164:167]
    s_waitcnt lgkmcnt(8)
    v_mfma_f32_16x16x32_bf16 v[168:171], a[124:127], v[196:199], v[168:171]
    s_waitcnt vmcnt(6)
    s_waitcnt lgkmcnt(6)
    v_mfma_f32_16x16x32_bf16 v[156:159], a[128:131], v[80:83], v[156:159]
    buffer_load_dwordx4 v[112:115], v24, s[40:43], s13 offen offset:2048 sc1
    s_waitcnt lgkmcnt(4)
    v_mfma_f32_16x16x32_bf16 v[160:163], a[132:135], v[80:83], v[160:163]
    s_waitcnt lgkmcnt(2)
    v_mfma_f32_16x16x32_bf16 v[164:167], a[136:139], v[80:83], v[164:167]
    s_waitcnt lgkmcnt(0)
    v_mfma_f32_16x16x32_bf16 v[168:171], a[140:143], v[80:83], v[168:171]
    s_nop 0
    v_cvt_pk_bf16_f32 v208, v156, v157
    v_cvt_pk_bf16_f32 v209, v158, v159
    ds_write_b64 v8, v[208:209] offset:0
    v_cvt_pk_bf16_f32 v210, v160, v161
    v_cvt_pk_bf16_f32 v211, v162, v163
    ds_write_b64 v8, v[210:211] offset:32
    v_cvt_pk_bf16_f32 v212, v164, v165
    v_cvt_pk_bf16_f32 v213, v166, v167
    ds_write_b64 v8, v[212:213] offset:64
    v_cvt_pk_bf16_f32 v214, v168, v169
    v_cvt_pk_bf16_f32 v215, v170, v171
    ds_write_b64 v8, v[214:215] offset:96
    ds_read_b128 v[208:211], v9 offset:0
    ds_read_b128 v[212:215], v9 offset:1152
    s_waitcnt vmcnt(6)
    v_mfma_f32_16x16x32_bf16 v[174:177], a[144:147], v[88:91], 0
    buffer_load_dwordx4 v[116:119], v24, s[40:43], s13 offen offset:3072 sc1
    v_mfma_f32_16x16x32_bf16 v[178:181], a[148:151], v[88:91], 0
    v_mfma_f32_16x16x32_bf16 v[182:185], a[152:155], v[88:91], 0
    v_mfma_f32_16x16x32_bf16 v[186:189], a[156:159], v[88:91], 0
    s_waitcnt vmcnt(6)
    v_mfma_f32_16x16x32_bf16 v[174:177], a[160:163], v[92:95], v[174:177]
    buffer_load_dwordx4 v[120:123], v24, s[40:43], s14 offen offset:0 sc1
    v_mfma_f32_16x16x32_bf16 v[178:181], a[164:167], v[92:95], v[178:181]
    v_mfma_f32_16x16x32_bf16 v[182:185], a[168:171], v[92:95], v[182:185]
    v_mfma_f32_16x16x32_bf16 v[186:189], a[172:175], v[92:95], v[186:189]
    s_waitcnt vmcnt(6)
    v_mfma_f32_16x16x32_bf16 v[174:177], a[176:179], v[96:99], v[174:177]
    buffer_load_dwordx4 v[124:127], v24, s[40:43], s14 offen offset:1024 sc1
    v_mfma_f32_16x16x32_bf16 v[178:181], a[180:183], v[96:99], v[178:181]
    v_mfma_f32_16x16x32_bf16 v[182:185], a[184:187], v[96:99], v[182:185]
    v_mfma_f32_16x16x32_bf16 v[186:189], a[188:191], v[96:99], v[186:189]
    s_waitcnt vmcnt(6)
    v_mfma_f32_16x16x32_bf16 v[174:177], a[192:195], v[100:103], v[174:177]
    buffer_load_dwordx4 v[128:131], v24, s[40:43], s14 offen offset:2048 sc1
    v_mfma_f32_16x16x32_bf16 v[178:181], a[196:199], v[100:103], v[178:181]
    v_mfma_f32_16x16x32_bf16 v[182:185], a[200:203], v[100:103], v[182:185]
    v_mfma_f32_16x16x32_bf16 v[186:189], a[204:207], v[100:103], v[186:189]
    s_waitcnt vmcnt(6)
    v_mfma_f32_16x16x32_bf16 v[174:177], a[208:211], v[104:107], v[174:177]
    buffer_load_dwordx4 v[132:135], v24, s[40:43], s14 offen offset:3072 sc1
    v_mfma_f32_16x16x32_bf16 v[178:181], a[212:215], v[104:107], v[178:181]
    v_mfma_f32_16x16x32_bf16 v[182:185], a[216:219], v[104:107], v[182:185]
    v_mfma_f32_16x16x32_bf16 v[186:189], a[220:223], v[104:107], v[186:189]
    s_waitcnt vmcnt(6)
    v_mfma_f32_16x16x32_bf16 v[174:177], a[224:227], v[108:111], v[174:177]
    buffer_load_dwordx4 v[200:203], v24, s[40:43], s15 offen offset:0 sc1
    v_mfma_f32_16x16x32_bf16 v[178:181], a[228:231], v[108:111], v[178:181]
    v_mfma_f32_16x16x32_bf16 v[182:185], a[232:235], v[108:111], v[182:185]
    v_mfma_f32_16x16x32_bf16 v[186:189], a[236:239], v[108:111], v[186:189]
    s_waitcnt vmcnt(6)
    v_mfma_f32_16x16x32_bf16 v[174:177], a[240:243], v[112:115], v[174:177]
    buffer_load_dwordx4 v[204:207], v24, s[40:43], s15 offen offset:1024 sc1
    v_mfma_f32_16x16x32_bf16 v[178:181], a[244:247], v[112:115], v[178:181]
    v_mfma_f32_16x16x32_bf16 v[182:185], a[248:251], v[112:115], v[182:185]
    v_mfma_f32_16x16x32_bf16 v[186:189], a[252:255], v[112:115], v[186:189]
    s_waitcnt vmcnt(6)
    v_mfma_f32_16x16x32_bf16 v[174:177], a[0:3], v[116:119], v[174:177]
    buffer_load_dwordx4 v[220:223], v24, s[40:43], s15 offen offset:2048 sc1
    v_mfma_f32_16x16x32_bf16 v[178:181], a[4:7], v[116:119], v[178:181]
    v_mfma_f32_16x16x32_bf16 v[182:185], a[8:11], v[116:119], v[182:185]
    v_mfma_f32_16x16x32_bf16 v[186:189], a[12:15], v[116:119], v[186:189]
    s_waitcnt vmcnt(6)
    v_mfma_f32_16x16x32_bf16 v[174:177], a[16:19], v[120:123], v[174:177]
    buffer_load_dwordx4 v[224:227], v24, s[40:43], s15 offen offset:3072 sc1
    v_mfma_f32_16x16x32_bf16 v[178:181], a[20:23], v[120:123], v[178:181]
    v_mfma_f32_16x16x32_bf16 v[182:185], a[24:27], v[120:123], v[182:185]
    v_mfma_f32_16x16x32_bf16 v[186:189], a[28:31], v[120:123], v[186:189]
    s_waitcnt vmcnt(6)
    v_mfma_f32_16x16x32_bf16 v[174:177], a[32:35], v[124:127], v[174:177]
    s_waitcnt lgkmcnt(0)
    buffer_store_dwordx4 v[208:211], v25, s[36:39], 0 offen nt
    v_mfma_f32_16x16x32_bf16 v[178:181], a[36:39], v[124:127], v[178:181]
    v_mfma_f32_16x16x32_bf16 v[182:185], a[40:43], v[124:127], v[182:185]
    v_mfma_f32_16x16x32_bf16 v[186:189], a[44:47], v[124:127], v[186:189]
    s_waitcnt vmcnt(6)
    v_mfma_f32_16x16x32_bf16 v[174:177], a[48:51], v[128:131], v[174:177]
    buffer_store_dwordx4 v[212:215], v25, s[36:39], s61 offen nt
    v_mfma_f32_16x16x32_bf16 v[178:181], a[52:55], v[128:131], v[178:181]
    v_mfma_f32_16x16x32_bf16 v[182:185], a[56:59], v[128:131], v[182:185]
    v_mfma_f32_16x16x32_bf16 v[186:189], a[60:63], v[128:131], v[186:189]
    s_waitcnt vmcnt(6)
    v_mfma_f32_16x16x32_bf16 v[174:177], a[64:67], v[132:135], v[174:177]
    v_mfma_f32_16x16x32_bf16 v[178:181], a[68:71], v[132:135], v[178:181]
    v_mfma_f32_16x16x32_bf16 v[182:185], a[72:75], v[132:135], v[182:185]
    v_mfma_f32_16x16x32_bf16 v[186:189], a[76:79], v[132:135], v[186:189]
    s_waitcnt vmcnt(5)
    v_mfma_f32_16x16x32_bf16 v[174:177], a[80:83], v[200:203], v[174:177]
    v_mfma_f32_16x16x32_bf16 v[178:181], a[84:87], v[200:203], v[178:181]
    v_mfma_f32_16x16x32_bf16 v[182:185], a[88:91], v[200:203], v[182:185]
    v_mfma_f32_16x16x32_bf16 v[186:189], a[92:95], v[200:203], v[186:189]
    s_waitcnt vmcnt(4)
    v_mfma_f32_16x16x32_bf16 v[174:177], a[96:99], v[204:207], v[174:177]
    v_mfma_f32_16x16x32_bf16 v[178:181], a[100:103], v[204:207], v[178:181]
    v_mfma_f32_16x16x32_bf16 v[182:185], a[104:107], v[204:207], v[182:185]
    v_mfma_f32_16x16x32_bf16 v[186:189], a[108:111], v[204:207], v[186:189]
    s_waitcnt vmcnt(3)
    v_mfma_f32_16x16x32_bf16 v[174:177], a[112:115], v[220:223], v[174:177]
    v_mfma_f32_16x16x32_bf16 v[178:181], a[116:119], v[220:223], v[178:181]
    v_mfma_f32_16x16x32_bf16 v[182:185], a[120:123], v[220:223], v[182:185]
    v_mfma_f32_16x16x32_bf16 v[186:189], a[124:127], v[220:223], v[186:189]
    s_waitcnt vmcnt(2)
    v_mfma_f32_16x16x32_bf16 v[174:177], a[128:131], v[224:227], v[174:177]
    v_mfma_f32_16x16x32_bf16 v[178:181], a[132:135], v[224:227], v[178:181]
    v_mfma_f32_16x16x32_bf16 v[182:185], a[136:139], v[224:227], v[182:185]
    v_mfma_f32_16x16x32_bf16 v[186:189], a[140:143], v[224:227], v[186:189]
    s_nop 4
    v_cvt_pk_bf16_f32 v228, v174, v175
    v_cvt_pk_bf16_f32 v229, v176, v177
    ds_write_b64 v8, v[228:229] offset:0
    v_cvt_pk_bf16_f32 v230, v178, v179
    v_cvt_pk_bf16_f32 v231, v180, v181
    ds_write_b64 v8, v[230:231] offset:32
    v_cvt_pk_bf16_f32 v232, v182, v183
    v_cvt_pk_bf16_f32 v233, v184, v185
    ds_write_b64 v8, v[232:233] offset:64
    v_cvt_pk_bf16_f32 v234, v186, v187
    v_cvt_pk_bf16_f32 v235, v188, v189
    ds_write_b64 v8, v[234:235] offset:96
    ds_read_b128 v[228:231], v9 offset:0
    ds_read_b128 v[232:235], v9 offset:1152
    s_waitcnt lgkmcnt(1)
    buffer_store_dwordx4 v[228:231], v25, s[36:39], s63 offen nt
    s_waitcnt lgkmcnt(0)
    buffer_store_dwordx4 v[232:235], v25, s[36:39], s62 offen nt
L_end:
L_last:
    s_endpgm
L_ros:
    s_mov_b32 s58, 0x40000
L_rosl:
    s_cmp_lg_u32 s10, 0
    s_cbranch_scc1 L_rosall
    buffer_load_dword v252, off, s[44:47], s12 sc1
    s_waitcnt vmcnt(0)
    v_readfirstlane_b32 s10, v252
    s_sub_u32 s58, s58, 1
    s_cmp_lg_u32 s58, 0
    s_cbranch_scc1 L_rosl
L_rosall:
    s_cmp_eq_u32 s10, s8
    s_cbranch_scc1 L_rosback
    s_mov_b32 s57, 0
    v_add_u32 v26, 128, v26
    s_branch L_rosback
L_slow0:
    buffer_store_dwordx4 v[236:239], v23, s[40:43], 0 offen sc1
    buffer_store_dwordx4 v[240:243], v23, s[40:43], s16 offen sc1
    s_branch L_join0
L_slow1:
    buffer_store_dword v30, v27, s[40:43], 0 offen offset:0 sc1
    buffer_store_dword v30, v27, s[40:43], 0 offen offset:128 sc1
    s_branch L_join1
L_slow2:
    buffer_store_dwordx4 v[244:247], v23, s[40:43], s17 offen sc1
    buffer_store_dwordx4 v[248:251], v23, s[40:43], s18 offen sc1
    s_branch L_join2
L_spin0:
    s_mov_b32 s58, 0x40000
    v_cmp_ne_u32 vcc, 0, v254
    s_nop 0
    s_cmp_eq_u64 vcc, -1
    s_cbranch_scc1 L_spine0
    s_waitcnt vmcnt(3)
    v_mov_b32 v254, v253
    v_cmp_ne_u32 vcc, 0, v254
    s_nop 0
    s_cmp_eq_u64 vcc, -1
    s_cbranch_scc1 L_spine0
    s_waitcnt vmcnt(2)
    v_mov_b32 v254, v255
L_spinl0:
    v_cmp_ne_u32 vcc, 0, v254
    s_nop 0
    s_cmp_eq_u64 vcc, -1
    s_cbranch_scc1 L_spine0
    buffer_load_dword v254, v26, s[40:43], 0 offen offset:0 sc1
    s_sub_u32 s58, s58, 1
    s_cmp_lg_u32 s58, 0
    s_waitcnt vmcnt(0)
    s_cbranch_scc1 L_spinl0
L_spine0:
    v_cmp_eq_u32 vcc, s8, v254
    s_nop 0
    s_cmp_eq_u64 vcc, -1
    s_cselect_b32 s57, s57, 0
    s_branch L_got0
L_slow3:
    buffer_store_dwordx4 v[236:239], v23, s[40:43], 0 offen sc1
    buffer_store_dwordx4 v[240:243], v23, s[40:43], s16 offen sc1
    buffer_store_dwordx4 v[244:247], v23, s[40:43], s17 offen sc1
    buffer_store_dwordx4 v[248:251], v23, s[40:43], s18 offen sc1
    s_waitcnt vmcnt(0)
    buffer_store_dword v30, v27, s[40:43], 0 offen offset:16 sc1
    buffer_store_dword v30, v27, s[40:43], 0 offen offset:128 sc1
    buffer_store_dword v30, v27, s[40:43], 0 offen offset:144 sc1
    s_branch L_join3
L_spin1:
    s_mov_b32 s58, 0x40000
L_spinl1:
    v_cmp_ne_u32 vcc, 0, v254
    s_nop 0
    s_cmp_eq_u64 vcc, -1
    s_cbranch_scc1 L_spine1
    buffer_load_dword v254, v26, s[40:43], 0 offen offset:16 sc1
    s_sub_u32 s58, s58, 1
    s_cmp_lg_u32 s58, 0
    s_waitcnt vmcnt(0)
    s_cbranch_scc1 L_spinl1
L_spine1:
    v_cmp_eq_u32 vcc, s8, v254
    s_nop 0
    s_cmp_eq_u64 vcc, -1
    s_cselect_b32 s57, s57, 0
    s_branch L_got1
.section .rodata,"a"
.p2align 6
.amdhsa_kernel concat_heads__sliding_local_dilated__sliding_local_dilated__prompt_kernel
  .amdhsa_next_free_vgpr 512
  .amdhsa_next_free_sgpr 102
  .amdhsa_accum_offset 256
  .amdhsa_group_segment_fixed_size 0
  .amdhsa_kernarg_size 72
  .amdhsa_user_sgpr_count 2
  .amdhsa_user_sgpr_kernarg_segment_ptr 1
  .amdhsa_system_sgpr_workgroup_id_x 1
  .amdhsa_float_denorm_mode_32 3
.end_amdhsa_kernel
```
